```python
import torch

def _softmax(x, axis=-1):
    return torch.softmax(x, dim=axis)
def _gelu(x):
    return torch.nn.functional.gelu(x, approximate="tanh")
def _silu(x):
    return torch.nn.functional.silu(x)
def _sigmoid(x):
    return torch.sigmoid(x)
def _layernorm(x, axis=-1, eps=1e-5):
    m = x.mean(dim=axis, keepdim=True)
    v = x.var(dim=axis, keepdim=True, unbiased=False)
    return (x - m) / torch.sqrt(v + eps)
def _scatter_add(tgt, idx, src, axis=0):
    return tgt.clone().index_add_(axis, idx, src)
def _segment_sum(src, seg, n):
    out = torch.zeros((n,) + src.shape[1:], dtype=src.dtype)
    return out.index_add_(0, seg, src)
def _pad(x, pw):
    flat = tuple(v for pair in reversed(pw) for v in pair)
    return torch.nn.functional.pad(x, flat)

kernel_name = 'gated_mix__mha_block__sliding_local_dilated__prompt'

def setup_inputs():

    _w = (lambda a: (lambda t: t.to(torch.bfloat16) if t.is_floating_point() else t)(torch.as_tensor(a)))
    def _A_setup():
        B, S, D, H = 1, 2048, 512, 32
        return {
            "x": _w((lambda *s: torch.randn(*s, dtype=torch.bfloat16) * 0.05)(B, S, D)),
            "wqkv": _w((lambda *s: torch.randn(*s, dtype=torch.bfloat16) * 1.6)(D, 3 * D)),
            "wo": _w((lambda *s: torch.randn(*s, dtype=torch.bfloat16) * 0.1)(D, D)),
        }
    _A_in = _A_setup()

    def _B_setup():
        B, S, D = 1, 2048, 512
        return {
            "x": _w((lambda *s: torch.randn(*s, dtype=torch.bfloat16) * 0.05)(B, S, D)),
            "wqkv": _w((lambda *s: torch.randn(*s, dtype=torch.bfloat16) * 1.6)(D, 3 * D)),
            "wo": _w((lambda *s: torch.randn(*s, dtype=torch.bfloat16) * 0.05)(D, D)),
        }
    _B_in = _B_setup()

    return {
        "A_x": _A_in["x"],
        "A_wqkv": _A_in["wqkv"],
        "A_wo": _A_in["wo"],
        "B_x": _B_in["x"],
        "B_wqkv": _B_in["wqkv"],
        "B_wo": _B_in["wo"],
        "gate_w": _w((lambda *s: torch.randn(*s, dtype=torch.bfloat16) * 0.05)(512) * 16.0),
    }

def reference(A_x, A_wqkv, A_wo, B_x, B_wqkv, B_wo, gate_w):
    def _A_ref(x, wqkv, wo):
        B, S, D = x.shape
        H = 32
        Dh = D // H
        qkv = (lambda x, *d: x.permute(*d))((x @ wqkv).reshape(B, S, 3, H, Dh), 2, 0, 3, 1, 4)
        q, k, v = qkv[0], qkv[1], qkv[2]
        scores = torch.einsum("bhqd,bhkd->bhqk", q, k) * (Dh ** -0.5)
        p = _softmax(scores, axis=-1)
        o = torch.einsum("bhqk,bhkd->bhqd", p, v)
        return (lambda x, *d: x.permute(*d))(o, 0, 2, 1, 3).reshape(B, S, D) @ wo

    def _B_ref(x, wqkv, wo):
        B, S, D = x.shape
        H = 32; Dh = D // H
        W, dil = 8, 2
        qkv = (lambda x, *d: x.permute(*d))((x @ wqkv).reshape(B, S, 3, H, Dh), 2, 0, 3, 1, 4)
        q, k, v = qkv[0], qkv[1], qkv[2]
        scale = Dh ** -0.5
        pos = torch.arange(S)
        off = torch.arange(W) * dil
        idx = pos[:, None] - off[None, :]
        mask = idx >= 0
        idx_c = torch.where(mask, idx, 0).reshape(-1)
        kg = k[:, :, idx_c, :].reshape(B, H, S, W, Dh)
        vg = v[:, :, idx_c, :].reshape(B, H, S, W, Dh)
        logits = torch.einsum("bhsd,bhswd->bhsw", q, kg) * scale
        logits = torch.where(mask[None, None, :, :], logits, -1e9)
        attn = _softmax(logits, axis=-1)
        o = torch.einsum("bhsw,bhswd->bhsd", attn, vg)
        return (lambda x, *d: x.permute(*d))(o, 0, 2, 1, 3).reshape(B, S, D) @ wo

    x = A_x
    g = _sigmoid((x * gate_w).sum(-1, keepdims=True))
    a = _A_ref(x, A_wqkv, A_wo)
    b = _B_ref(x, B_wqkv, B_wo)
    return g * a + (1 - g) * b
```

```asm
; @launch grid=(256,1,1) block=(512,1,1) lds=163840
.amdgcn_target "amdgcn-amd-amdhsa--gfx950"
.text
.globl gated_mix__mha_block__sliding_local_dilated__prompt_kernel
.p2align 8
.type gated_mix__mha_block__sliding_local_dilated__prompt_kernel,@function
gated_mix__mha_block__sliding_local_dilated__prompt_kernel:
  s_cmp_ge_u32 s2, 256
  s_cbranch_scc1 Lend
  s_load_dwordx4 s[4:7], s[0:1], 0
  s_load_dwordx2 s[10:11], s[0:1], 32
  v_lshrrev_b32 v1, 6, v0
  s_and_b32 s56, s2, 7
  v_readfirstlane_b32 s40, v1
  v_and_b32 v1, 63, v0
  s_lshr_b32 s57, s2, 3
  s_and_b32 s41, s56, 1
  s_lshl_b32 s41, s41, 3
  s_and_b32 s58, s57, 7
  s_add_u32 s41, s41, s58
  s_lshr_b32 s43, s56, 1
  s_lshr_b32 s44, s57, 3
  s_lshr_b32 s42, s44, 1
  s_lshl_b32 s45, s56, 2
  s_add_u32 s45, s45, s44
  s_lshl_b32 s46, s58, 3
  s_add_u32 s46, s46, s40
  s_lshr_b32 s47, s40, 2
  s_and_b32 s48, s40, 3
  s_lshl_b32 s50, s41, 17
  s_lshl_b32 s58, s40, 13
  s_add_u32 s50, s50, s58
  s_lshl_b32 s62, s43, 1
  s_and_b32 s58, s44, 1
  s_add_u32 s62, s62, s58
  s_lshl_b32 s58, s42, 1
  s_add_u32 s62, s62, s58
  s_and_b32 s62, s62, 7
  s_lshl_b32 s58, s42, 2
  s_xor_b32 s63, s62, s58
  s_xor_b32 s63, s63, 4
  s_mul_i32 s64, s40, 8*3072
  s_lshl_b32 s58, s62, 7
  s_add_u32 s51, s64, s58
  s_add_u32 s51, s51, 1024
  s_lshl_b32 s52, s40, 10
  s_and_b32 s59, s40, 1
  s_and_b32 s54, s57, 3
  s_lshl_b32 s54, s54, 1
  s_add_u32 s54, s54, s56
  v_lshlrev_b32 v2, 4, v1
  v_lshrrev_b32 v9, 3, v1
  v_and_b32 v10, 7, v1
  v_lshrrev_b32 v30, 4, v1
  v_xor_b32 v12, v10, v30
  v_lshlrev_b32 v12, 4, v12
  v_lshl_add_u32 v4, v9, 10, v12
  s_lshl_b32 s58, s59, 6
  v_xor_b32 v3, s58, v4
  v_and_b32 v12, 1, v30
  v_lshlrev_b32 v12, 5, v12
  v_xor_b32 v12, s58, v12
  v_lshlrev_b32 v13, 4, v10
  v_xor_b32 v12, v12, v13
  v_mul_u32_u24 v6, 3072, v9
  v_add_u32 v6, v6, v12
  s_getpc_b64 s[60:61]
Lpc:
  s_cmp_lg_u32 s40, 0
  s_cbranch_scc1 Lnocpf
  s_mul_i32 s58, s57, 1536
  v_lshl_add_u32 v18, v1, 7, s58
  v_min_u32 v18, Lcode_end-Lpc-4, v18
  s_mov_b64 exec, 0xfff
  global_load_dword v31, v18, s[60:61]
  s_mov_b64 exec, -1
Lnocpf:
  s_waitcnt lgkmcnt(0)
  s_load_dwordx2 s[14:15], s[0:1], 48
  s_load_dwordx2 s[96:97], s[0:1], 72
  s_load_dwordx2 s[8:9], s[0:1], 16
  s_load_dwordx2 s[12:13], s[0:1], 40
  s_load_dwordx2 s[66:67], s[0:1], 56
  s_load_dwordx2 s[100:101], s[0:1], 64
  s_mov_b32 s16, s4
  s_mov_b32 s17, s5
  s_mov_b32 s18, 2097152
  s_mov_b32 s19, 0x20000
  s_cmp_eq_u32 s42, 0
  s_cselect_b32 s20, s6, s10
  s_cselect_b32 s21, s7, s11
  s_mov_b32 s22, 512*3072
  s_mov_b32 s23, 0x20000
  s_add_u32 s60, s54, 0
  s_and_b32 s60, s60, 7
  s_lshl_b32 s60, s60, 7
  s_add_u32 m0, s52, 0
  s_add_u32 s60, s60, s50
  buffer_load_dwordx4 v3, s[16:19], s60 offen lds
  s_add_u32 s55, s54, 0
  s_and_b32 s55, s55, 7
  s_mul_i32 s55, s55, 196608
  s_add_u32 m0, s52, 65536
  s_add_u32 s55, s55, s51
  buffer_load_dwordx4 v6, s[20:23], s55 offen lds
  s_add_u32 s60, s54, 0
  s_and_b32 s60, s60, 7
  s_lshl_b32 s60, s60, 7
  s_add_u32 m0, s52, 8192
  s_add_u32 s60, s60, s50
  s_add_u32 s60, s60, 65536
  buffer_load_dwordx4 v3, s[16:19], s60 offen lds
  s_add_u32 m0, s52, 73728
  s_add_u32 s60, s55, 1024
  buffer_load_dwordx4 v6, s[20:23], s60 offen lds
  s_waitcnt lgkmcnt(0)
  s_mov_b32 s28, s96
  s_mov_b32 s29, s97
  s_mov_b32 s30, 268435456
  s_mov_b32 s31, 0x20000
  s_mov_b32 s36, s14
  s_mov_b32 s37, s15
  s_mov_b32 s38, 1024
  s_mov_b32 s39, 0x20000
  s_mov_b32 s5, s62
  s_mov_b32 s10, s63
  s_lshl_b32 s58, s63, 7
  s_add_u32 s4, s64, s58
  s_lshl_b32 s58, s2, 3
  s_add_u32 s58, s58, s40
  s_cmp_lg_u32 s58, 1027
  s_cbranch_scc1 Lnoscan1
  s_mov_b32 s60, 10485760
  s_mov_b32 s59, 10493952
  s_mov_b32 s58, 10502144
  v_lshlrev_b32 v18, 7, v1
  buffer_load_dwordx4 v[240:243], v2, s[28:31], s60 offen sc1
  buffer_load_dwordx4 v[244:247], v18, s[28:31], s58 offen sc1
  buffer_load_dwordx2 v[248:249], v18, s[28:31], s59 offen sc1
Lnoscan1:
  s_mov_b32 s32, s100
  s_mov_b32 s33, s101
  s_mov_b32 s34, 256
  s_mov_b32 s35, 0x20000
  v_and_b32 v29, 15, v1
  v_lshrrev_b32 v16, 1, v29
  v_xor_b32 v16, v16, v30
  v_lshlrev_b32 v16, 4, v16
  v_lshl_add_u32 v16, v29, 7, v16
  s_lshl_b32 s58, s48, 12
  v_add_u32 v7, s58, v16
  v_xor_b32 v8, 64, v7
  v_lshlrev_b32 v11, 4, v30
  s_lshl_b32 s58, s47, 9
  s_add_u32 s58, s58, 139264
  v_add_u32 v11, s58, v11
  v_bfe_u32 v18, v1, 2, 2
  v_lshl_add_u32 v14, v30, 3, v18
  v_lshlrev_b32 v14, 7, v14
  v_bfe_u32 v18, v1, 3, 2
  s_lshl_b32 s58, s47, 1
  v_xor_b32 v18, s58, v18
  v_lshl_add_u32 v14, v18, 5, v14
  v_and_b32 v18, 3, v1
  v_lshl_add_u32 v14, v18, 3, v14
  v_xor_b32 v15, 32, v14
  v_add_u32 v12, 65536, v14
  v_add_u32 v13, 65536, v15
  v_mov_b32 v20, 0
  v_and_b32 v24, 31, v1
  v_lshlrev_b32 v24, 2, v24
  s_lshl_b32 s56, s45, 6
  s_add_u32 s57, s56, s46
  s_lshl_b32 s15, s57, 10
  s_add_u32 s56, s56, s40
  s_lshl_b32 s56, s56, 11
  s_add_u32 s62, s56, 2097152
  s_mul_i32 s65, s40, 2080
  s_mov_b32 s53, 0
  s_lshl_b32 s56, s46, 6
  s_add_u32 s56, s56, s45
  s_lshl_b32 s56, s56, 10
  s_add_u32 s14, s56, 6291456
  s_lshl_b32 s58, s41, 2
  s_add_u32 s58, s58, s48
  s_lshl_b32 s59, s47, 1
  s_lshl_b32 s57, s5, 2
  s_add_u32 s57, s57, s59
  s_lshl_b32 s56, s58, 6
  s_add_u32 s56, s56, s57
  s_lshl_b32 s56, s56, 10
  s_add_u32 s64, s56, 6324224
  s_lshl_b32 s56, s57, 6
  s_add_u32 s56, s56, s58
  s_lshl_b32 s56, s56, 11
  s_add_u32 s6, s56, 2097152
  s_add_u32 s92, s6, 131072
  s_lshl_b32 s56, s5, 10
  s_lshr_b32 s60, s41, 1
  s_lshl_b32 s60, s60, 7
  s_add_u32 s56, s56, s60
  s_and_b32 s60, s41, 1
  s_lshl_b32 s60, s60, 2
  s_add_u32 s56, s56, s60
  s_add_u32 s56, s56, 10493952
  s_cmp_eq_u32 s40, 0
  s_cselect_b32 s93, s56, 0
  s_mov_b32 s95, 0
  s_mov_b32 s0, 0x7ff00000
  s_mov_b32 s100, 0x3eb8aa3b
  s_cmp_eq_u32 s42, 0
  s_cbranch_scc1 Lisa
  s_lshl_b32 s56, s5, 4
  s_add_u32 s56, s56, s41
  s_lshl_b32 s56, s56, 1
  s_add_u32 s56, s56, s47
  s_lshl_b32 s60, s56, 11
  s_add_u32 s60, s60, 12582912
  s_sub_u32 s95, s56, 2
  s_lshr_b32 s61, s56, 2
  s_lshl_b32 s61, s61, 5
  s_and_b32 s56, s56, 3
  s_add_u32 s56, s56, s61
  s_lshl_b32 s56, s56, 2
  s_add_u32 s56, s56, 10502144
  s_lshr_b32 s61, s95, 2
  s_lshl_b32 s61, s61, 5
  s_and_b32 s95, s95, 3
  s_add_u32 s95, s95, s61
  s_lshl_b32 s95, s95, 2
  s_add_u32 s95, s95, 10502144
  s_sub_u32 s94, s60, 4096
  s_cmp_eq_u32 s41, 0
  s_cselect_b32 s94, 0x7ff00000, s94
  s_cselect_b32 s95, 0, s95
  s_cmp_eq_u32 s48, 0
  s_cselect_b32 s95, s95, 0
  s_cmp_eq_u32 s48, 3
  s_cselect_b32 s0, s60, 0x7ff00000
  s_cselect_b32 s93, s56, 0
  s_mov_b32 s6, 0x7ff00000
  s_mov_b32 s92, 0x7ff00000
    Lisa:
  s_lshl_b32 s57, s10, 2
  s_add_u32 s57, s57, s59
  s_lshl_b32 s56, s57, 6
  s_add_u32 s56, s56, s58
  s_lshl_b32 s7, s56, 10
  s_cmp_eq_u32 s42, 0
  s_cselect_b32 s7, s7, 0x7ff00000
  s_mov_b32 s63, 10493952
  s_lshl_b32 s56, s47, 11
  s_lshl_b32 s57, s48, 12
  s_add_u32 s56, s56, s57
  s_add_u32 s3, s56, 143360
  s_and_b32 s56, s2, 7
  s_lshl_b32 s57, s56, 10
  s_xor_b32 s56, s57, 4096
  s_lshr_b32 s60, s46, 3
  s_lshl_b32 s60, s60, 7
  s_add_u32 s56, s56, s60
  v_lshrrev_b32 v18, 1, v29
  v_lshl_add_u32 v18, v18, 7, s57
  v_mov_b32 v19, s56
  s_mov_b32 vcc_lo, -1
  s_mov_b32 vcc_hi, 0
  v_cndmask_b32 v18, v19, v18, vcc
  v_and_b32 v19, 1, v1
  v_lshl_add_u32 v9, v19, 2, v18
  v_add_u32 v10, s3, v2
  v_add_u32 v23, 141312, v2
  v_mov_b32 v64, -1
  v_mov_b32 v65, -1
  v_mov_b32 v66, -1
  v_mov_b32 v67, -1
  v_lshrrev_b32 v18, 5, v1
  v_lshlrev_b32 v16, 9, v18
  v_lshl_add_u32 v16, v29, 4, v16
  v_add_u32 v16, 1024, v16
  v_add_u32 v17, 256, v16
  v_mov_b32 v19, 2064
  v_mov_b32 v18, 2048
  s_mov_b32 vcc_lo, 0x00110000
  s_mov_b32 vcc_hi, 0x00110000
  v_cndmask_b32 v19, v19, v18, vcc
  s_mov_b32 vcc_lo, 0x0000ffff
  s_mov_b32 vcc_hi, 0x0000ffff
  v_cndmask_b32 v16, v19, v16, vcc
  v_cndmask_b32 v17, v19, v17, vcc
  v_mov_b32 v25, 140288
  s_lshl_b32 s58, s48, 8
  s_add_u32 s58, s58, 141312
  s_lshl_b32 s59, s47, 2
  s_add_u32 s59, s59, s58
  v_lshl_add_u32 v27, v24, 1, s59
  v_mov_b32 v21, 0
  v_lshl_add_u32 v18, v29, 2, v25
  ds_write_b32 v18, v20
  s_lshl_b32 s58, s42, 3
  s_add_u32 s58, s58, s40
  s_cmp_lg_u32 s58, 9
  s_cbranch_scc1 Lnomask0
  v_mov_b32 v18, 0xf149f2ca
  s_mov_b32 vcc_lo, 0x5555
  s_mov_b32 vcc_hi, 0x55550
  v_cndmask_b32 v32, v18, v20, vcc
  s_mov_b32 vcc_lo, 0xaaaa
  s_mov_b32 vcc_hi, 0xaaaa0
  v_cndmask_b32 v33, v18, v20, vcc
  s_mov_b32 vcc_lo, 0x15554
  s_mov_b32 vcc_hi, 0x155540
  v_cndmask_b32 v34, v18, v20, vcc
  s_mov_b32 vcc_lo, 0x2aaa8
  s_mov_b32 vcc_hi, 0x2aaa80
  v_cndmask_b32 v35, v18, v20, vcc
  s_mov_b32 vcc_lo, 0x555500
  s_mov_b32 vcc_hi, 0x5555000
  v_cndmask_b32 v36, v18, v20, vcc
  s_mov_b32 vcc_lo, 0xaaaa00
  s_mov_b32 vcc_hi, 0xaaaa000
  v_cndmask_b32 v37, v18, v20, vcc
  s_mov_b32 vcc_lo, 0x1555400
  s_mov_b32 vcc_hi, 0x15554000
  v_cndmask_b32 v38, v18, v20, vcc
  s_mov_b32 vcc_lo, 0x2aaa800
  s_mov_b32 vcc_hi, 0x2aaa8000
  v_cndmask_b32 v39, v18, v20, vcc
  v_add_u32 v22, 141312, v2
  ds_write_b128 v22, v[32:35]
  ds_write_b128 v22, v[36:39] offset:1024
  s_waitcnt lgkmcnt(0)
Lnomask0:
  s_lshl_b32 s58, s42, 3
  s_add_u32 s58, s58, s40
  s_cmp_lg_u32 s58, 10
  s_cbranch_scc1 Lnomask1
  v_mov_b32 v18, 0xf149f2ca
  s_mov_b32 vcc_lo, 0x55550000
  s_mov_b32 vcc_hi, 0x55500000
  v_cndmask_b32 v32, v18, v20, vcc
  s_mov_b32 vcc_lo, 0xaaaa0000
  s_mov_b32 vcc_hi, 0xaaa00000
  v_cndmask_b32 v33, v18, v20, vcc
  s_mov_b32 vcc_lo, 0x55540000
  s_mov_b32 vcc_hi, 0x55400000
  v_cndmask_b32 v34, v18, v20, vcc
  s_mov_b32 vcc_lo, 0xaaa80000
  s_mov_b32 vcc_hi, 0xaa800000
  v_cndmask_b32 v35, v18, v20, vcc
  s_mov_b32 vcc_lo, 0x55000000
  s_mov_b32 vcc_hi, 0x50000000
  v_cndmask_b32 v36, v18, v20, vcc
  s_mov_b32 vcc_lo, 0xaa000000
  s_mov_b32 vcc_hi, 0xa0000000
  v_cndmask_b32 v37, v18, v20, vcc
  s_mov_b32 vcc_lo, 0x54000000
  s_mov_b32 vcc_hi, 0x40000000
  v_cndmask_b32 v38, v18, v20, vcc
  s_mov_b32 vcc_lo, 0xa8000000
  s_mov_b32 vcc_hi, 0x80000000
  v_cndmask_b32 v39, v18, v20, vcc
  v_add_u32 v22, 143360, v2
  ds_write_b128 v22, v[32:35]
  ds_write_b128 v22, v[36:39] offset:1024
  s_waitcnt lgkmcnt(0)
Lnomask1:
  s_lshl_b32 s58, s42, 3
  s_add_u32 s58, s58, s40
  s_cmp_lg_u32 s58, 11
  s_cbranch_scc1 Lnomask2
  v_mov_b32 v18, 0xf149f2ca
  s_mov_b32 vcc_lo, 0x0
  s_mov_b32 vcc_hi, 0x5
  v_cndmask_b32 v32, v18, v20, vcc
  s_mov_b32 vcc_lo, 0x0
  s_mov_b32 vcc_hi, 0xa
  v_cndmask_b32 v33, v18, v20, vcc
  s_mov_b32 vcc_lo, 0x1
  s_mov_b32 vcc_hi, 0x15
  v_cndmask_b32 v34, v18, v20, vcc
  s_mov_b32 vcc_lo, 0x2
  s_mov_b32 vcc_hi, 0x2a
  v_cndmask_b32 v35, v18, v20, vcc
  s_mov_b32 vcc_lo, 0x55
  s_mov_b32 vcc_hi, 0x555
  v_cndmask_b32 v36, v18, v20, vcc
  s_mov_b32 vcc_lo, 0xaa
  s_mov_b32 vcc_hi, 0xaaa
  v_cndmask_b32 v37, v18, v20, vcc
  s_mov_b32 vcc_lo, 0x155
  s_mov_b32 vcc_hi, 0x1555
  v_cndmask_b32 v38, v18, v20, vcc
  s_mov_b32 vcc_lo, 0x2aa
  s_mov_b32 vcc_hi, 0x2aaa
  v_cndmask_b32 v39, v18, v20, vcc
  v_add_u32 v22, 145408, v2
  ds_write_b128 v22, v[32:35]
  ds_write_b128 v22, v[36:39] offset:1024
  s_waitcnt lgkmcnt(0)
Lnomask2:
  s_lshl_b32 s58, s2, 3
  s_add_u32 s58, s58, s40
  s_cmp_lg_u32 s58, 1027
  s_cbranch_scc1 Lnoscan2
  s_waitcnt vmcnt(0)
  s_mov_b32 s60, 0
Lscan:
  s_add_u32 s60, s60, 1
  s_mov_b64 exec, -1
  v_cmpx_ne_u32 vcc, s60, v240
  v_cmpx_ne_u32 vcc, s60, v241
  v_cmpx_ne_u32 vcc, s60, v242
  v_cmpx_ne_u32 vcc, s60, v243
  v_cmpx_ne_u32 vcc, s60, v244
  v_cmpx_ne_u32 vcc, s60, v245
  v_cmpx_ne_u32 vcc, s60, v246
  v_cmpx_ne_u32 vcc, s60, v247
  v_cmpx_ne_u32 vcc, s60, v248
  v_cmpx_ne_u32 vcc, s60, v249
  s_nop 1
  s_cmp_eq_u64 exec, -1
  s_cbranch_scc0 Lscan
  v_mov_b32 v21, s60
  s_mov_b64 exec, 1
  buffer_store_dword v21, v20, s[32:35], 0 offen sc1
  s_mov_b64 exec, -1
Lnoscan2:
  v_and_b32 v18, 3, v1
  v_lshrrev_b32 v5, 2, v1
  v_lshlrev_b32 v5, 10, v5
  v_lshl_add_u32 v5, v18, 4, v5
  v_bfe_u32 v19, v1, 2, 2
  v_lshrrev_b32 v26, 5, v1
  v_lshl_add_u32 v26, v26, 2, v19
  v_lshlrev_b32 v26, 6, v26
  v_bfe_u32 v19, v1, 4, 1
  v_lshl_add_u32 v26, v19, 5, v26
  v_lshl_add_u32 v26, v18, 3, v26
  s_add_u32 s58, s52, 147456
  v_add_u32 v26, s58, v26
  s_add_u32 s60, s54, 1
  s_and_b32 s60, s60, 7
  s_lshl_b32 s60, s60, 7
  s_add_u32 m0, s52, 16384
  s_add_u32 s60, s60, s50
  buffer_load_dwordx4 v3, s[16:19], s60 offen lds
  s_add_u32 s55, s54, 1
  s_and_b32 s55, s55, 7
  s_mul_i32 s55, s55, 196608
  s_add_u32 m0, s52, 81920
  s_add_u32 s55, s55, s51
  buffer_load_dwordx4 v6, s[20:23], s55 offen lds
  s_add_u32 s60, s54, 1
  s_and_b32 s60, s60, 7
  s_lshl_b32 s60, s60, 7
  s_add_u32 m0, s52, 24576
  s_add_u32 s60, s60, s50
  s_add_u32 s60, s60, 65536
  buffer_load_dwordx4 v3, s[16:19], s60 offen lds
  s_add_u32 m0, s52, 90112
  s_add_u32 s60, s55, 1024
  buffer_load_dwordx4 v6, s[20:23], s60 offen lds
  s_add_u32 s60, s40, s54
  s_and_b32 s60, s60, 7
  s_lshl_b32 s60, s60, 7
  s_lshl_b32 s59, s40, 7
  s_add_u32 m0, s59, 139264
  s_mov_b64 exec, 0xff
  buffer_load_dwordx4 v2, s[36:39], s60 offen lds
  s_mov_b64 exec, -1
  s_waitcnt vmcnt(5)
  s_barrier
  ds_read_b128 v[128:131], v7 offset:0
  ds_read_b64_tr_b16 v[68:69], v12 offset:0
  ds_read_b64_tr_b16 v[70:71], v12 offset:512
  ds_read_b128 v[132:135], v7 offset:2048
  ds_read_b64_tr_b16 v[72:73], v13 offset:0
  ds_read_b64_tr_b16 v[74:75], v13 offset:512
  ds_read_b64_tr_b16 v[76:77], v12 offset:8192
  ds_read_b64_tr_b16 v[78:79], v12 offset:8704
  ds_read_b64_tr_b16 v[80:81], v13 offset:8192
  ds_read_b64_tr_b16 v[82:83], v13 offset:8704
  s_cmp_lg_u32 s47, 0
  s_cbranch_scc1 LV1
LV0:
  s_waitcnt lgkmcnt(7)
  v_mfma_f32_16x16x32_bf16 v[32:35], v[68:71], v[128:131], 0
  ds_read_b128 v[136:139], v8 offset:0
  ds_read_b64_tr_b16 v[92:93], v12 offset:4096
  s_waitcnt lgkmcnt(8)
  v_mfma_f32_16x16x32_bf16 v[36:39], v[68:71], v[132:135], 0
  ds_read_b64_tr_b16 v[94:95], v12 offset:4608
  ds_read_b128 v[140:143], v8 offset:2048
  s_waitcnt lgkmcnt(8)
  v_mfma_f32_16x16x32_bf16 v[40:43], v[72:75], v[128:131], 0
  ds_read_b64_tr_b16 v[96:97], v13 offset:4096
  ds_read_b64_tr_b16 v[98:99], v13 offset:4608
  v_mfma_f32_16x16x32_bf16 v[44:47], v[72:75], v[132:135], 0
  ds_read_b64_tr_b16 v[100:101], v12 offset:12288
  s_waitcnt lgkmcnt(9)
  v_mfma_f32_16x16x32_bf16 v[48:51], v[128:131], v[76:79], 0
  ds_read_b64_tr_b16 v[102:103], v12 offset:12800
  v_mfma_f32_16x16x32_bf16 v[52:55], v[132:135], v[76:79], 0
  ds_read_b64_tr_b16 v[104:105], v13 offset:12288
  s_waitcnt lgkmcnt(9)
  v_mfma_f32_16x16x32_bf16 v[56:59], v[128:131], v[80:83], 0
  ds_read_b64_tr_b16 v[106:107], v13 offset:12800
  v_mfma_f32_16x16x32_bf16 v[60:63], v[132:135], v[80:83], 0
  s_waitcnt vmcnt(0)
  s_barrier
  s_waitcnt lgkmcnt(7)
  v_mfma_f32_16x16x32_bf16 v[32:35], v[92:95], v[136:139], v[32:35]
  ds_read_b128 v[144:147], v7 offset:16384
  ds_read_b64_tr_b16 v[68:69], v12 offset:16384
  s_waitcnt lgkmcnt(8)
  v_mfma_f32_16x16x32_bf16 v[36:39], v[92:95], v[140:143], v[36:39]
  ds_read_b64_tr_b16 v[70:71], v12 offset:16896
  ds_read_b128 v[148:151], v7 offset:18432
  s_waitcnt lgkmcnt(8)
  v_mfma_f32_16x16x32_bf16 v[40:43], v[96:99], v[136:139], v[40:43]
  ds_read_b64_tr_b16 v[72:73], v13 offset:16384
  ds_read_b64_tr_b16 v[74:75], v13 offset:16896
  v_mfma_f32_16x16x32_bf16 v[44:47], v[96:99], v[140:143], v[44:47]
  ds_read_b64_tr_b16 v[76:77], v12 offset:24576
  s_waitcnt lgkmcnt(9)
  v_mfma_f32_16x16x32_bf16 v[48:51], v[136:139], v[100:103], v[48:51]
  ds_read_b64_tr_b16 v[78:79], v12 offset:25088
  v_mfma_f32_16x16x32_bf16 v[52:55], v[140:143], v[100:103], v[52:55]
  ds_read_b64_tr_b16 v[80:81], v13 offset:24576
  s_waitcnt lgkmcnt(9)
  v_mfma_f32_16x16x32_bf16 v[56:59], v[136:139], v[104:107], v[56:59]
  ds_read_b64_tr_b16 v[82:83], v13 offset:25088
  v_mfma_f32_16x16x32_bf16 v[60:63], v[140:143], v[104:107], v[60:63]
  s_waitcnt lgkmcnt(7)
  v_mfma_f32_16x16x32_bf16 v[32:35], v[68:71], v[144:147], v[32:35]
  ds_read_b128 v[152:155], v8 offset:16384
  ds_read_b64_tr_b16 v[92:93], v12 offset:20480
  s_waitcnt lgkmcnt(8)
  v_mfma_f32_16x16x32_bf16 v[36:39], v[68:71], v[148:151], v[36:39]
  ds_read_b64_tr_b16 v[94:95], v12 offset:20992
  ds_read_b128 v[156:159], v8 offset:18432
  s_waitcnt lgkmcnt(8)
  v_mfma_f32_16x16x32_bf16 v[40:43], v[72:75], v[144:147], v[40:43]
  ds_read_b64_tr_b16 v[96:97], v13 offset:20480
  ds_read_b64_tr_b16 v[98:99], v13 offset:20992
  v_mfma_f32_16x16x32_bf16 v[44:47], v[72:75], v[148:151], v[44:47]
  ds_read_b64_tr_b16 v[100:101], v12 offset:28672
  s_waitcnt lgkmcnt(9)
  v_mfma_f32_16x16x32_bf16 v[48:51], v[144:147], v[76:79], v[48:51]
  ds_read_b64_tr_b16 v[102:103], v12 offset:29184
  v_mfma_f32_16x16x32_bf16 v[52:55], v[148:151], v[76:79], v[52:55]
  ds_read_b64_tr_b16 v[104:105], v13 offset:28672
  s_waitcnt lgkmcnt(9)
  v_mfma_f32_16x16x32_bf16 v[56:59], v[144:147], v[80:83], v[56:59]
  ds_read_b64_tr_b16 v[106:107], v13 offset:29184
  v_mfma_f32_16x16x32_bf16 v[60:63], v[148:151], v[80:83], v[60:63]
  s_barrier
  s_waitcnt lgkmcnt(7)
  v_mfma_f32_16x16x32_bf16 v[32:35], v[92:95], v[152:155], v[32:35]
  ds_read_b128 v[160:163], v7 offset:32768
  ds_read_b64_tr_b16 v[68:69], v12 offset:32768
  s_waitcnt lgkmcnt(8)
  v_mfma_f32_16x16x32_bf16 v[36:39], v[92:95], v[156:159], v[36:39]
  ds_read_b64_tr_b16 v[70:71], v12 offset:33280
  ds_read_b128 v[164:167], v7 offset:34816
  s_waitcnt lgkmcnt(8)
  v_mfma_f32_16x16x32_bf16 v[40:43], v[96:99], v[152:155], v[40:43]
  ds_read_b64_tr_b16 v[72:73], v13 offset:32768
  ds_read_b64_tr_b16 v[74:75], v13 offset:33280
  v_mfma_f32_16x16x32_bf16 v[44:47], v[96:99], v[156:159], v[44:47]
  ds_read_b64_tr_b16 v[76:77], v12 offset:40960
  s_waitcnt lgkmcnt(9)
  v_mfma_f32_16x16x32_bf16 v[48:51], v[152:155], v[100:103], v[48:51]
  ds_read_b64_tr_b16 v[78:79], v12 offset:41472
  v_mfma_f32_16x16x32_bf16 v[52:55], v[156:159], v[100:103], v[52:55]
  ds_read_b64_tr_b16 v[80:81], v13 offset:40960
  s_waitcnt lgkmcnt(9)
  v_mfma_f32_16x16x32_bf16 v[56:59], v[152:155], v[104:107], v[56:59]
  ds_read_b64_tr_b16 v[82:83], v13 offset:41472
  v_mfma_f32_16x16x32_bf16 v[60:63], v[156:159], v[104:107], v[60:63]
  s_waitcnt lgkmcnt(7)
  v_mfma_f32_16x16x32_bf16 v[32:35], v[68:71], v[160:163], v[32:35]
  ds_read_b128 v[168:171], v8 offset:32768
  ds_read_b64_tr_b16 v[92:93], v12 offset:36864
  s_waitcnt lgkmcnt(8)
  v_mfma_f32_16x16x32_bf16 v[36:39], v[68:71], v[164:167], v[36:39]
  ds_read_b64_tr_b16 v[94:95], v12 offset:37376
  ds_read_b128 v[172:175], v8 offset:34816
  s_waitcnt lgkmcnt(8)
  v_mfma_f32_16x16x32_bf16 v[40:43], v[72:75], v[160:163], v[40:43]
  ds_read_b64_tr_b16 v[96:97], v13 offset:36864
  ds_read_b64_tr_b16 v[98:99], v13 offset:37376
  v_mfma_f32_16x16x32_bf16 v[44:47], v[72:75], v[164:167], v[44:47]
  ds_read_b64_tr_b16 v[100:101], v12 offset:45056
  s_waitcnt lgkmcnt(9)
  v_mfma_f32_16x16x32_bf16 v[48:51], v[160:163], v[76:79], v[48:51]
  ds_read_b64_tr_b16 v[102:103], v12 offset:45568
  v_mfma_f32_16x16x32_bf16 v[52:55], v[164:167], v[76:79], v[52:55]
  ds_read_b64_tr_b16 v[104:105], v13 offset:45056
  s_waitcnt lgkmcnt(9)
  v_mfma_f32_16x16x32_bf16 v[56:59], v[160:163], v[80:83], v[56:59]
  ds_read_b64_tr_b16 v[106:107], v13 offset:45568
  v_mfma_f32_16x16x32_bf16 v[60:63], v[164:167], v[80:83], v[60:63]
  s_barrier
  s_add_u32 s56, s7, 65536
  buffer_store_dwordx4 v[64:67], v2, s[28:31], s7 offen sc1
  buffer_store_dwordx4 v[64:67], v2, s[28:31], s56 offen sc1
  s_waitcnt lgkmcnt(7)
  v_mfma_f32_16x16x32_bf16 v[32:35], v[92:95], v[168:171], v[32:35]
  ds_read_b128 v[176:179], v7 offset:49152
  ds_read_b64_tr_b16 v[68:69], v12 offset:49152
  s_waitcnt lgkmcnt(8)
  v_mfma_f32_16x16x32_bf16 v[36:39], v[92:95], v[172:175], v[36:39]
  ds_read_b64_tr_b16 v[70:71], v12 offset:49664
  ds_read_b128 v[180:183], v7 offset:51200
  s_waitcnt lgkmcnt(8)
  v_mfma_f32_16x16x32_bf16 v[40:43], v[96:99], v[168:171], v[40:43]
  ds_read_b64_tr_b16 v[72:73], v13 offset:49152
  ds_read_b64_tr_b16 v[74:75], v13 offset:49664
  v_mfma_f32_16x16x32_bf16 v[44:47], v[96:99], v[172:175], v[44:47]
  ds_read_b64_tr_b16 v[76:77], v12 offset:57344
  s_waitcnt lgkmcnt(9)
  v_mfma_f32_16x16x32_bf16 v[48:51], v[168:171], v[100:103], v[48:51]
  ds_read_b64_tr_b16 v[78:79], v12 offset:57856
  v_mfma_f32_16x16x32_bf16 v[52:55], v[172:175], v[100:103], v[52:55]
  ds_read_b64_tr_b16 v[80:81], v13 offset:57344
  s_waitcnt lgkmcnt(9)
  v_mfma_f32_16x16x32_bf16 v[56:59], v[168:171], v[104:107], v[56:59]
  ds_read_b64_tr_b16 v[82:83], v13 offset:57856
  v_mfma_f32_16x16x32_bf16 v[60:63], v[172:175], v[104:107], v[60:63]
  s_waitcnt lgkmcnt(7)
  v_mfma_f32_16x16x32_bf16 v[32:35], v[68:71], v[176:179], v[32:35]
  ds_read_b128 v[184:187], v8 offset:49152
  ds_read_b64_tr_b16 v[92:93], v12 offset:53248
  s_waitcnt lgkmcnt(8)
  v_mfma_f32_16x16x32_bf16 v[36:39], v[68:71], v[180:183], v[36:39]
  ds_read_b64_tr_b16 v[94:95], v12 offset:53760
  ds_read_b128 v[188:191], v8 offset:51200
  s_waitcnt lgkmcnt(8)
  v_mfma_f32_16x16x32_bf16 v[40:43], v[72:75], v[176:179], v[40:43]
  ds_read_b64_tr_b16 v[96:97], v13 offset:53248
  ds_read_b64_tr_b16 v[98:99], v13 offset:53760
  v_mfma_f32_16x16x32_bf16 v[44:47], v[72:75], v[180:183], v[44:47]
  ds_read_b64_tr_b16 v[100:101], v12 offset:61440
  s_waitcnt lgkmcnt(9)
  v_mfma_f32_16x16x32_bf16 v[48:51], v[176:179], v[76:79], v[48:51]
  ds_read_b64_tr_b16 v[102:103], v12 offset:61952
  v_mfma_f32_16x16x32_bf16 v[52:55], v[180:183], v[76:79], v[52:55]
  ds_read_b64_tr_b16 v[104:105], v13 offset:61440
  s_waitcnt lgkmcnt(9)
  v_mfma_f32_16x16x32_bf16 v[56:59], v[176:179], v[80:83], v[56:59]
  ds_read_b64_tr_b16 v[106:107], v13 offset:61952
  v_mfma_f32_16x16x32_bf16 v[60:63], v[180:183], v[80:83], v[60:63]
  s_barrier
  s_waitcnt lgkmcnt(7)
  v_mfma_f32_16x16x32_bf16 v[32:35], v[92:95], v[184:187], v[32:35]
  ds_read_b128 v[192:195], v7 offset:0
  ds_read_b64_tr_b16 v[68:69], v12 offset:0
  s_waitcnt lgkmcnt(8)
  v_mfma_f32_16x16x32_bf16 v[36:39], v[92:95], v[188:191], v[36:39]
  ds_read_b64_tr_b16 v[70:71], v12 offset:512
  ds_read_b128 v[196:199], v7 offset:2048
  s_waitcnt lgkmcnt(8)
  v_mfma_f32_16x16x32_bf16 v[40:43], v[96:99], v[184:187], v[40:43]
  ds_read_b64_tr_b16 v[72:73], v13 offset:0
  ds_read_b64_tr_b16 v[74:75], v13 offset:512
  v_mfma_f32_16x16x32_bf16 v[44:47], v[96:99], v[188:191], v[44:47]
  ds_read_b64_tr_b16 v[76:77], v12 offset:8192
  s_waitcnt lgkmcnt(9)
  v_mfma_f32_16x16x32_bf16 v[48:51], v[184:187], v[100:103], v[48:51]
  ds_read_b64_tr_b16 v[78:79], v12 offset:8704
  v_mfma_f32_16x16x32_bf16 v[52:55], v[188:191], v[100:103], v[52:55]
  ds_read_b64_tr_b16 v[80:81], v13 offset:8192
  s_waitcnt lgkmcnt(9)
  v_mfma_f32_16x16x32_bf16 v[56:59], v[184:187], v[104:107], v[56:59]
  ds_read_b64_tr_b16 v[82:83], v13 offset:8704
  v_mfma_f32_16x16x32_bf16 v[60:63], v[188:191], v[104:107], v[60:63]
  s_waitcnt lgkmcnt(7)
  v_mfma_f32_16x16x32_bf16 v[32:35], v[68:71], v[192:195], v[32:35]
  ds_read_b128 v[200:203], v8 offset:0
  ds_read_b64_tr_b16 v[92:93], v12 offset:4096
  s_waitcnt lgkmcnt(8)
  v_mfma_f32_16x16x32_bf16 v[36:39], v[68:71], v[196:199], v[36:39]
  ds_read_b64_tr_b16 v[94:95], v12 offset:4608
  ds_read_b128 v[204:207], v8 offset:2048
  s_waitcnt lgkmcnt(8)
  v_mfma_f32_16x16x32_bf16 v[40:43], v[72:75], v[192:195], v[40:43]
  ds_read_b64_tr_b16 v[96:97], v13 offset:4096
  ds_read_b64_tr_b16 v[98:99], v13 offset:4608
  v_mfma_f32_16x16x32_bf16 v[44:47], v[72:75], v[196:199], v[44:47]
  ds_read_b64_tr_b16 v[100:101], v12 offset:12288
  s_waitcnt lgkmcnt(9)
  v_mfma_f32_16x16x32_bf16 v[48:51], v[192:195], v[76:79], v[48:51]
  ds_read_b64_tr_b16 v[102:103], v12 offset:12800
  v_mfma_f32_16x16x32_bf16 v[52:55], v[196:199], v[76:79], v[52:55]
  ds_read_b64_tr_b16 v[104:105], v13 offset:12288
  s_waitcnt lgkmcnt(9)
  v_mfma_f32_16x16x32_bf16 v[56:59], v[192:195], v[80:83], v[56:59]
  ds_read_b64_tr_b16 v[106:107], v13 offset:12800
  v_mfma_f32_16x16x32_bf16 v[60:63], v[196:199], v[80:83], v[60:63]
  s_barrier
  s_waitcnt lgkmcnt(7)
  v_mfma_f32_16x16x32_bf16 v[32:35], v[92:95], v[200:203], v[32:35]
  ds_read_b128 v[208:211], v7 offset:16384
  ds_read_b64_tr_b16 v[68:69], v12 offset:16384
  s_waitcnt lgkmcnt(8)
  v_mfma_f32_16x16x32_bf16 v[36:39], v[92:95], v[204:207], v[36:39]
  ds_read_b64_tr_b16 v[70:71], v12 offset:16896
  ds_read_b128 v[212:215], v7 offset:18432
  s_waitcnt lgkmcnt(8)
  v_mfma_f32_16x16x32_bf16 v[40:43], v[96:99], v[200:203], v[40:43]
  ds_read_b64_tr_b16 v[72:73], v13 offset:16384
  ds_read_b64_tr_b16 v[74:75], v13 offset:16896
  v_mfma_f32_16x16x32_bf16 v[44:47], v[96:99], v[204:207], v[44:47]
  ds_read_b64_tr_b16 v[76:77], v12 offset:24576
  s_waitcnt lgkmcnt(9)
  v_mfma_f32_16x16x32_bf16 v[48:51], v[200:203], v[100:103], v[48:51]
  ds_read_b64_tr_b16 v[78:79], v12 offset:25088
  v_mfma_f32_16x16x32_bf16 v[52:55], v[204:207], v[100:103], v[52:55]
  ds_read_b64_tr_b16 v[80:81], v13 offset:24576
  s_waitcnt lgkmcnt(9)
  v_mfma_f32_16x16x32_bf16 v[56:59], v[200:203], v[104:107], v[56:59]
  ds_read_b64_tr_b16 v[82:83], v13 offset:25088
  v_mfma_f32_16x16x32_bf16 v[60:63], v[204:207], v[104:107], v[60:63]
  s_waitcnt lgkmcnt(7)
  v_mfma_f32_16x16x32_bf16 v[32:35], v[68:71], v[208:211], v[32:35]
  ds_read_b128 v[216:219], v8 offset:16384
  ds_read_b64_tr_b16 v[92:93], v12 offset:20480
  s_waitcnt lgkmcnt(8)
  v_mfma_f32_16x16x32_bf16 v[36:39], v[68:71], v[212:215], v[36:39]
  ds_read_b64_tr_b16 v[94:95], v12 offset:20992
  ds_read_b128 v[220:223], v8 offset:18432
  s_waitcnt lgkmcnt(8)
  v_mfma_f32_16x16x32_bf16 v[40:43], v[72:75], v[208:211], v[40:43]
  ds_read_b64_tr_b16 v[96:97], v13 offset:20480
  ds_read_b64_tr_b16 v[98:99], v13 offset:20992
  v_mfma_f32_16x16x32_bf16 v[44:47], v[72:75], v[212:215], v[44:47]
  ds_read_b64_tr_b16 v[100:101], v12 offset:28672
  s_waitcnt lgkmcnt(9)
  v_mfma_f32_16x16x32_bf16 v[48:51], v[208:211], v[76:79], v[48:51]
  ds_read_b64_tr_b16 v[102:103], v12 offset:29184
  v_mfma_f32_16x16x32_bf16 v[52:55], v[212:215], v[76:79], v[52:55]
  ds_read_b64_tr_b16 v[104:105], v13 offset:28672
  s_waitcnt lgkmcnt(9)
  v_mfma_f32_16x16x32_bf16 v[56:59], v[208:211], v[80:83], v[56:59]
  ds_read_b64_tr_b16 v[106:107], v13 offset:29184
  v_mfma_f32_16x16x32_bf16 v[60:63], v[212:215], v[80:83], v[60:63]
  s_barrier
  s_waitcnt lgkmcnt(7)
  v_mfma_f32_16x16x32_bf16 v[32:35], v[92:95], v[216:219], v[32:35]
  ds_read_b128 v[224:227], v7 offset:32768
  ds_read_b64_tr_b16 v[68:69], v12 offset:32768
  s_waitcnt lgkmcnt(8)
  v_mfma_f32_16x16x32_bf16 v[36:39], v[92:95], v[220:223], v[36:39]
  ds_read_b64_tr_b16 v[70:71], v12 offset:33280
  ds_read_b128 v[228:231], v7 offset:34816
  s_waitcnt lgkmcnt(8)
  v_mfma_f32_16x16x32_bf16 v[40:43], v[96:99], v[216:219], v[40:43]
  ds_read_b64_tr_b16 v[72:73], v13 offset:32768
  ds_read_b64_tr_b16 v[74:75], v13 offset:33280
  v_mfma_f32_16x16x32_bf16 v[44:47], v[96:99], v[220:223], v[44:47]
  ds_read_b64_tr_b16 v[76:77], v12 offset:40960
  s_waitcnt lgkmcnt(9)
  v_mfma_f32_16x16x32_bf16 v[48:51], v[216:219], v[100:103], v[48:51]
  ds_read_b64_tr_b16 v[78:79], v12 offset:41472
  v_mfma_f32_16x16x32_bf16 v[52:55], v[220:223], v[100:103], v[52:55]
  ds_read_b64_tr_b16 v[80:81], v13 offset:40960
  s_waitcnt lgkmcnt(9)
  v_mfma_f32_16x16x32_bf16 v[56:59], v[216:219], v[104:107], v[56:59]
  ds_read_b64_tr_b16 v[82:83], v13 offset:41472
  v_mfma_f32_16x16x32_bf16 v[60:63], v[220:223], v[104:107], v[60:63]
  s_waitcnt lgkmcnt(7)
  v_mfma_f32_16x16x32_bf16 v[32:35], v[68:71], v[224:227], v[32:35]
  ds_read_b128 v[232:235], v8 offset:32768
  ds_read_b64_tr_b16 v[92:93], v12 offset:36864
  s_waitcnt lgkmcnt(8)
  v_mfma_f32_16x16x32_bf16 v[36:39], v[68:71], v[228:231], v[36:39]
  ds_read_b64_tr_b16 v[94:95], v12 offset:37376
  ds_read_b128 v[236:239], v8 offset:34816
  s_waitcnt lgkmcnt(8)
  v_mfma_f32_16x16x32_bf16 v[40:43], v[72:75], v[224:227], v[40:43]
  ds_read_b64_tr_b16 v[96:97], v13 offset:36864
  ds_read_b64_tr_b16 v[98:99], v13 offset:37376
  v_mfma_f32_16x16x32_bf16 v[44:47], v[72:75], v[228:231], v[44:47]
  ds_read_b64_tr_b16 v[100:101], v12 offset:45056
  s_waitcnt lgkmcnt(9)
  v_mfma_f32_16x16x32_bf16 v[48:51], v[224:227], v[76:79], v[48:51]
  ds_read_b64_tr_b16 v[102:103], v12 offset:45568
  v_mfma_f32_16x16x32_bf16 v[52:55], v[228:231], v[76:79], v[52:55]
  ds_read_b64_tr_b16 v[104:105], v13 offset:45056
  s_waitcnt lgkmcnt(9)
  v_mfma_f32_16x16x32_bf16 v[56:59], v[224:227], v[80:83], v[56:59]
  ds_read_b64_tr_b16 v[106:107], v13 offset:45568
  v_mfma_f32_16x16x32_bf16 v[60:63], v[228:231], v[80:83], v[60:63]
  s_barrier
  s_waitcnt lgkmcnt(7)
  v_mfma_f32_16x16x32_bf16 v[32:35], v[92:95], v[232:235], v[32:35]
  ds_read_b128 v[240:243], v7 offset:49152
  ds_read_b64_tr_b16 v[68:69], v12 offset:49152
  s_waitcnt lgkmcnt(8)
  v_mfma_f32_16x16x32_bf16 v[36:39], v[92:95], v[236:239], v[36:39]
  ds_read_b64_tr_b16 v[70:71], v12 offset:49664
  ds_read_b128 v[244:247], v7 offset:51200
  s_waitcnt lgkmcnt(8)
  v_mfma_f32_16x16x32_bf16 v[40:43], v[96:99], v[232:235], v[40:43]
  ds_read_b64_tr_b16 v[72:73], v13 offset:49152
  ds_read_b64_tr_b16 v[74:75], v13 offset:49664
  v_mfma_f32_16x16x32_bf16 v[44:47], v[96:99], v[236:239], v[44:47]
  ds_read_b64_tr_b16 v[76:77], v12 offset:57344
  s_waitcnt lgkmcnt(9)
  v_mfma_f32_16x16x32_bf16 v[48:51], v[232:235], v[100:103], v[48:51]
  ds_read_b64_tr_b16 v[78:79], v12 offset:57856
  v_mfma_f32_16x16x32_bf16 v[52:55], v[236:239], v[100:103], v[52:55]
  ds_read_b64_tr_b16 v[80:81], v13 offset:57344
  s_waitcnt lgkmcnt(9)
  v_mfma_f32_16x16x32_bf16 v[56:59], v[232:235], v[104:107], v[56:59]
  ds_read_b64_tr_b16 v[82:83], v13 offset:57856
  v_mfma_f32_16x16x32_bf16 v[60:63], v[236:239], v[104:107], v[60:63]
  s_waitcnt lgkmcnt(7)
  v_mfma_f32_16x16x32_bf16 v[32:35], v[68:71], v[240:243], v[32:35]
  ds_read_b128 v[248:251], v8 offset:49152
  ds_read_b64_tr_b16 v[92:93], v12 offset:53248
  s_waitcnt lgkmcnt(8)
  v_mfma_f32_16x16x32_bf16 v[36:39], v[68:71], v[244:247], v[36:39]
  ds_read_b64_tr_b16 v[94:95], v12 offset:53760
  ds_read_b128 v[252:255], v8 offset:51200
  s_waitcnt lgkmcnt(8)
  v_mfma_f32_16x16x32_bf16 v[40:43], v[72:75], v[240:243], v[40:43]
  ds_read_b64_tr_b16 v[96:97], v13 offset:53248
  ds_read_b64_tr_b16 v[98:99], v13 offset:53760
  v_mfma_f32_16x16x32_bf16 v[44:47], v[72:75], v[244:247], v[44:47]
  ds_read_b64_tr_b16 v[100:101], v12 offset:61440
  s_waitcnt lgkmcnt(9)
  v_mfma_f32_16x16x32_bf16 v[48:51], v[240:243], v[76:79], v[48:51]
  ds_read_b64_tr_b16 v[102:103], v12 offset:61952
  v_mfma_f32_16x16x32_bf16 v[52:55], v[244:247], v[76:79], v[52:55]
  ds_read_b64_tr_b16 v[104:105], v13 offset:61440
  s_waitcnt lgkmcnt(9)
  v_mfma_f32_16x16x32_bf16 v[56:59], v[240:243], v[80:83], v[56:59]
  ds_read_b64_tr_b16 v[106:107], v13 offset:61952
  v_mfma_f32_16x16x32_bf16 v[60:63], v[244:247], v[80:83], v[60:63]
  s_waitcnt lgkmcnt(7)
  v_mfma_f32_16x16x32_bf16 v[32:35], v[92:95], v[248:251], v[32:35]
  s_waitcnt lgkmcnt(6)
  v_mfma_f32_16x16x32_bf16 v[36:39], v[92:95], v[252:255], v[36:39]
  s_waitcnt lgkmcnt(4)
  v_mfma_f32_16x16x32_bf16 v[40:43], v[96:99], v[248:251], v[40:43]
  v_mfma_f32_16x16x32_bf16 v[44:47], v[96:99], v[252:255], v[44:47]
  s_waitcnt lgkmcnt(2)
  v_mfma_f32_16x16x32_bf16 v[48:51], v[248:251], v[100:103], v[48:51]
  v_mfma_f32_16x16x32_bf16 v[52:55], v[252:255], v[100:103], v[52:55]
  s_waitcnt lgkmcnt(0)
  v_mfma_f32_16x16x32_bf16 v[56:59], v[248:251], v[104:107], v[56:59]
  v_mfma_f32_16x16x32_bf16 v[60:63], v[252:255], v[104:107], v[60:63]
  s_nop 1
  v_cvt_pk_bf16_f32 v116, v32, v33
  v_cvt_pk_bf16_f32 v117, v34, v35
  v_cvt_pk_bf16_f32 v118, v36, v37
  v_cvt_pk_bf16_f32 v119, v38, v39
  v_cvt_pk_bf16_f32 v120, v40, v41
  v_cvt_pk_bf16_f32 v121, v42, v43
  v_cvt_pk_bf16_f32 v122, v44, v45
  v_cvt_pk_bf16_f32 v123, v46, v47
  v_permlane16_swap_b32 v116, v118
  v_permlane16_swap_b32 v117, v119
  buffer_store_dwordx4 v[116:119], v2, s[28:31], s6 offen sc1
  v_cvt_pk_bf16_f32 v124, v48, v49
  v_cvt_pk_bf16_f32 v125, v50, v51
  v_cvt_pk_bf16_f32 v126, v52, v53
  v_cvt_pk_bf16_f32 v127, v54, v55
  v_permlane16_swap_b32 v120, v122
  v_permlane16_swap_b32 v121, v123
  buffer_store_dwordx4 v[120:123], v2, s[28:31], s92 offen sc1
  v_cvt_pk_bf16_f32 v32, v56, v57
  v_cvt_pk_bf16_f32 v33, v58, v59
  v_cvt_pk_bf16_f32 v34, v60, v61
  v_cvt_pk_bf16_f32 v35, v62, v63
  v_permlane16_swap_b32 v124, v126
  v_permlane16_swap_b32 v125, v127
  buffer_store_dwordx4 v[124:127], v2, s[28:31], s6 offen offset:1024 sc1
  v_permlane16_swap_b32 v32, v34
  v_permlane16_swap_b32 v33, v35
  buffer_store_dwordx4 v[32:35], v2, s[28:31], s92 offen offset:1024 sc1
  s_cmp_eq_u32 s42, 0
  s_cbranch_scc1 Lnbp_0
  v_mov_b32 v44, 0x3f803f80
  s_mov_b32 vcc_lo, 0x00110011
  s_mov_b32 vcc_hi, 0x00110011
  v_cndmask_b32 v44, 0, v44, vcc
  v_mov_b32 v36, v44
  v_mov_b32 v37, v44
  v_mov_b32 v38, v44
  v_mov_b32 v39, v44
  v_mov_b32 v40, v44
  v_mov_b32 v41, v44
  v_mov_b32 v42, v44
  v_mov_b32 v43, v44
  s_mov_b32 vcc_lo, 0xffff0000
  s_mov_b32 vcc_hi, 0xffff0000
  v_permlane16_swap_b32 v124, v36
  v_permlane16_swap_b32 v125, v37
  v_permlane16_swap_b32 v126, v38
  v_permlane16_swap_b32 v127, v39
  v_permlane16_swap_b32 v32, v40
  v_permlane16_swap_b32 v33, v41
  v_permlane16_swap_b32 v34, v42
  v_permlane16_swap_b32 v35, v43
  v_cndmask_b32 v84, v36, v116, vcc
  v_cndmask_b32 v85, v37, v117, vcc
  v_cndmask_b32 v86, v38, v118, vcc
  v_cndmask_b32 v87, v39, v119, vcc
  ds_write_b128 v10, v[84:87] offset:4096
  v_cndmask_b32 v88, v40, v120, vcc
  v_cndmask_b32 v89, v41, v121, vcc
  v_cndmask_b32 v90, v42, v122, vcc
  v_cndmask_b32 v91, v43, v123, vcc
  ds_write_b128 v10, v[88:91] offset:5120
  s_waitcnt lgkmcnt(0)
Lnbp_0:
  buffer_store_dwordx4 v[84:87], v2, s[28:31], s0 offen sc1
  buffer_store_dwordx4 v[88:91], v2, s[28:31], s0 offen offset:1024 sc1
  buffer_load_dword v21, v20, s[32:35], 0 offen sc1
  s_barrier
  ds_read_b64_tr_b16 v[68:69], v14 offset:0
  ds_read_b64_tr_b16 v[70:71], v14 offset:512
  ds_read_b64_tr_b16 v[72:73], v15 offset:0
  ds_read_b64_tr_b16 v[74:75], v15 offset:512
  ds_read_b64_tr_b16 v[76:77], v14 offset:4096
  ds_read_b64_tr_b16 v[78:79], v14 offset:4608
  ds_read_b64_tr_b16 v[80:81], v15 offset:4096
  ds_read_b64_tr_b16 v[82:83], v15 offset:4608
  s_waitcnt lgkmcnt(6)
  v_mfma_f32_16x16x32_bf16 v[48:51], v[68:71], v[128:131], 0
  ds_read_b64_tr_b16 v[92:93], v14 offset:8192
  ds_read_b64_tr_b16 v[94:95], v14 offset:8704
  v_mfma_f32_16x16x32_bf16 v[52:55], v[68:71], v[132:135], 0
  ds_read_b64_tr_b16 v[96:97], v15 offset:8192
  s_waitcnt lgkmcnt(7)
  v_mfma_f32_16x16x32_bf16 v[56:59], v[72:75], v[128:131], 0
  ds_read_b64_tr_b16 v[98:99], v15 offset:8704
  v_mfma_f32_16x16x32_bf16 v[60:63], v[72:75], v[132:135], 0
  ds_read_b64_tr_b16 v[100:101], v14 offset:12288
  s_waitcnt lgkmcnt(7)
  v_mfma_f32_16x16x32_bf16 v[48:51], v[76:79], v[136:139], v[48:51]
  ds_read_b64_tr_b16 v[102:103], v14 offset:12800
  v_mfma_f32_16x16x32_bf16 v[52:55], v[76:79], v[140:143], v[52:55]
  ds_read_b64_tr_b16 v[104:105], v15 offset:12288
  s_waitcnt lgkmcnt(7)
  v_mfma_f32_16x16x32_bf16 v[56:59], v[80:83], v[136:139], v[56:59]
  ds_read_b64_tr_b16 v[106:107], v15 offset:12800
  v_mfma_f32_16x16x32_bf16 v[60:63], v[80:83], v[140:143], v[60:63]
  s_barrier
  s_and_b32 s56, s2, 7
  s_lshl_b32 s56, s56, 3
  s_bfe_u32 s57, s2, 0x30003
  s_add_u32 s56, s56, s57
  s_cmp_lt_u32 s56, 32
  s_cselect_b32 s24, s8, s12
  s_cselect_b32 s25, s9, s13
  s_mov_b32 s26, 512*1024
  s_mov_b32 s27, 0x20000
  s_lshl_b32 s57, s44, 3
  s_add_u32 s57, s57, s40
  s_lshl_b32 s58, s57, 6
  s_add_u32 s58, s58, s56
  s_lshl_b32 s58, s58, 10
  s_add_u32 s58, s58, 11534336
  s_and_b32 s56, s56, 31
  s_lshl_b32 s56, s56, 14
  s_lshl_b32 s57, s57, 6
  s_add_u32 s56, s56, s57
  s_cmp_eq_u32 s42, 0
  s_cselect_b32 s64, s58, s64
  s_cselect_b32 s6, s56, 0x7ff00000
  s_waitcnt lgkmcnt(6)
  v_mfma_f32_16x16x32_bf16 v[48:51], v[92:95], v[144:147], v[48:51]
  ds_read_b64_tr_b16 v[68:69], v12 offset:0
  ds_read_b64_tr_b16 v[70:71], v12 offset:512
  v_mov_b32 v64, 0x3f803f80
  v_mfma_f32_16x16x32_bf16 v[52:55], v[92:95], v[148:151], v[52:55]
  ds_read_b64_tr_b16 v[72:73], v13 offset:0
  s_mov_b32 vcc_lo, 0x55555555
  s_mov_b32 vcc_hi, 0x55555555
  v_cndmask_b32 v64, 0, v64, vcc
  s_waitcnt lgkmcnt(7)
  v_mfma_f32_16x16x32_bf16 v[56:59], v[96:99], v[144:147], v[56:59]
  ds_read_b64_tr_b16 v[74:75], v13 offset:512
  v_mov_b32 v65, v64
  v_mfma_f32_16x16x32_bf16 v[60:63], v[96:99], v[148:151], v[60:63]
  ds_read_b64_tr_b16 v[76:77], v12 offset:4096
  v_mov_b32 v66, v64
  s_waitcnt lgkmcnt(7)
  v_mfma_f32_16x16x32_bf16 v[48:51], v[100:103], v[152:155], v[48:51]
  ds_read_b64_tr_b16 v[78:79], v12 offset:4608
  v_mov_b32 v67, v64
  v_mfma_f32_16x16x32_bf16 v[52:55], v[100:103], v[156:159], v[52:55]
  ds_read_b64_tr_b16 v[80:81], v13 offset:4096
  v_lshrrev_b32 v7, 1, v1
  s_waitcnt lgkmcnt(7)
  v_mfma_f32_16x16x32_bf16 v[56:59], v[104:107], v[152:155], v[56:59]
  ds_read_b64_tr_b16 v[82:83], v13 offset:4608
  v_and_b32 v8, 1, v1
  v_mfma_f32_16x16x32_bf16 v[60:63], v[104:107], v[156:159], v[60:63]
  v_mul_u32_u24 v4, 16640, v7
  s_waitcnt lgkmcnt(6)
  v_mfma_f32_16x16x32_bf16 v[48:51], v[68:71], v[160:163], v[48:51]
  ds_read_b64_tr_b16 v[92:93], v12 offset:8192
  ds_read_b64_tr_b16 v[94:95], v12 offset:8704
  v_lshl_add_u32 v4, v8, 4, v4
  v_mfma_f32_16x16x32_bf16 v[52:55], v[68:71], v[164:167], v[52:55]
  ds_read_b64_tr_b16 v[96:97], v13 offset:8192
  v_add_u32 v4, s65, v4
  s_waitcnt lgkmcnt(7)
  v_mfma_f32_16x16x32_bf16 v[56:59], v[72:75], v[160:163], v[56:59]
  ds_read_b64_tr_b16 v[98:99], v13 offset:8704
  v_lshrrev_b32 v3, 5, v1
  v_mfma_f32_16x16x32_bf16 v[60:63], v[72:75], v[164:167], v[60:63]
  ds_read_b64_tr_b16 v[100:101], v12 offset:12288
  v_mov_b32 v7, v16
  s_waitcnt lgkmcnt(7)
  v_mfma_f32_16x16x32_bf16 v[48:51], v[76:79], v[168:171], v[48:51]
  ds_read_b64_tr_b16 v[102:103], v12 offset:12800
  v_mov_b32 v8, v17
  v_mfma_f32_16x16x32_bf16 v[52:55], v[76:79], v[172:175], v[52:55]
  ds_read_b64_tr_b16 v[104:105], v13 offset:12288
  ds_read_b128 v[84:87], v10 offset:0
  s_waitcnt lgkmcnt(8)
  v_mfma_f32_16x16x32_bf16 v[56:59], v[80:83], v[168:171], v[56:59]
  ds_read_b64_tr_b16 v[106:107], v13 offset:12800
  ds_read_b128 v[88:91], v10 offset:1024
  v_mfma_f32_16x16x32_bf16 v[60:63], v[80:83], v[172:175], v[60:63]
  s_waitcnt vmcnt(0)
  s_barrier
  s_mov_b32 s61, 0
Lnonce_0:
  v_readfirstlane_b32 s49, v21
  s_add_u32 s61, s61, 1
  s_cmp_lg_u32 s49, 0
  s_cbranch_scc1 Lnonce_0_ok
  s_cmp_gt_u32 s61, 262144
  s_cbranch_scc1 Lnonce_0_ok
  s_sleep 2
  buffer_load_dword v21, v20, s[32:35], 0 offen sc1
  s_waitcnt vmcnt(0)
  s_branch Lnonce_0
Lnonce_0_ok:
  s_cmp_eq_u32 s93, 0
  s_cbranch_scc1 Lnofl_0
  s_mov_b64 exec, 1
  buffer_store_dword v21, v20, s[28:31], s93 offen sc1
  s_mov_b64 exec, -1
Lnofl_0:
  s_waitcnt lgkmcnt(8)
  v_mfma_f32_16x16x32_bf16 v[48:51], v[92:95], v[176:179], v[48:51]
  ds_read_b64_tr_b16 v[68:69], v14 offset:16384
  ds_read_b64_tr_b16 v[70:71], v14 offset:16896
  v_mfma_f32_16x16x32_bf16 v[52:55], v[92:95], v[180:183], v[52:55]
  ds_read_b64_tr_b16 v[72:73], v15 offset:16384
  s_waitcnt lgkmcnt(9)
  v_mfma_f32_16x16x32_bf16 v[56:59], v[96:99], v[176:179], v[56:59]
  ds_read_b64_tr_b16 v[74:75], v15 offset:16896
  v_mfma_f32_16x16x32_bf16 v[60:63], v[96:99], v[180:183], v[60:63]
  ds_read_b64_tr_b16 v[76:77], v14 offset:20480
  s_waitcnt lgkmcnt(9)
  v_mfma_f32_16x16x32_bf16 v[48:51], v[100:103], v[184:187], v[48:51]
  ds_read_b64_tr_b16 v[78:79], v14 offset:20992
  v_mfma_f32_16x16x32_bf16 v[52:55], v[100:103], v[188:191], v[52:55]
  ds_read_b64_tr_b16 v[80:81], v15 offset:20480
  s_waitcnt lgkmcnt(8)
  v_mfma_f32_16x16x32_bf16 v[56:59], v[104:107], v[184:187], v[56:59]
  ds_read_b64_tr_b16 v[82:83], v15 offset:20992
  v_mfma_f32_16x16x32_bf16 v[60:63], v[104:107], v[188:191], v[60:63]
  s_waitcnt lgkmcnt(6)
  v_mfma_f32_16x16x32_bf16 v[48:51], v[68:71], v[192:195], v[48:51]
  ds_read_b64_tr_b16 v[92:93], v14 offset:24576
  ds_read_b64_tr_b16 v[94:95], v14 offset:25088
  v_mfma_f32_16x16x32_bf16 v[52:55], v[68:71], v[196:199], v[52:55]
  ds_read_b64_tr_b16 v[96:97], v15 offset:24576
  s_waitcnt lgkmcnt(7)
  v_mfma_f32_16x16x32_bf16 v[56:59], v[72:75], v[192:195], v[56:59]
  ds_read_b64_tr_b16 v[98:99], v15 offset:25088
  v_mfma_f32_16x16x32_bf16 v[60:63], v[72:75], v[196:199], v[60:63]
  ds_read_b64_tr_b16 v[100:101], v14 offset:28672
  s_waitcnt lgkmcnt(7)
  v_mfma_f32_16x16x32_bf16 v[48:51], v[76:79], v[200:203], v[48:51]
  ds_read_b64_tr_b16 v[102:103], v14 offset:29184
  v_mfma_f32_16x16x32_bf16 v[52:55], v[76:79], v[204:207], v[52:55]
  ds_read_b64_tr_b16 v[104:105], v15 offset:28672
  s_waitcnt lgkmcnt(7)
  v_mfma_f32_16x16x32_bf16 v[56:59], v[80:83], v[200:203], v[56:59]
  ds_read_b64_tr_b16 v[106:107], v15 offset:29184
  v_mfma_f32_16x16x32_bf16 v[60:63], v[80:83], v[204:207], v[60:63]
  s_barrier
  s_cmp_eq_u32 s95, 0
  s_cbranch_scc1 Lnohp_0
  buffer_load_dword v0, v20, s[28:31], s95 offen sc1
Lnohp_0:
  s_waitcnt lgkmcnt(6)
  v_mfma_f32_16x16x32_bf16 v[48:51], v[92:95], v[208:211], v[48:51]
  ds_read_b64_tr_b16 v[68:69], v12 offset:16384
  ds_read_b64_tr_b16 v[70:71], v12 offset:16896
  v_mfma_f32_16x16x32_bf16 v[52:55], v[92:95], v[212:215], v[52:55]
  ds_read_b64_tr_b16 v[72:73], v13 offset:16384
  s_waitcnt lgkmcnt(7)
  v_mfma_f32_16x16x32_bf16 v[56:59], v[96:99], v[208:211], v[56:59]
  ds_read_b64_tr_b16 v[74:75], v13 offset:16896
  v_mfma_f32_16x16x32_bf16 v[60:63], v[96:99], v[212:215], v[60:63]
  ds_read_b64_tr_b16 v[76:77], v12 offset:20480
  s_waitcnt lgkmcnt(7)
  v_mfma_f32_16x16x32_bf16 v[48:51], v[100:103], v[216:219], v[48:51]
  ds_read_b64_tr_b16 v[78:79], v12 offset:20992
  v_mfma_f32_16x16x32_bf16 v[52:55], v[100:103], v[220:223], v[52:55]
  ds_read_b64_tr_b16 v[80:81], v13 offset:20480
  s_waitcnt lgkmcnt(7)
  v_mfma_f32_16x16x32_bf16 v[56:59], v[104:107], v[216:219], v[56:59]
  ds_read_b64_tr_b16 v[82:83], v13 offset:20992
  v_mfma_f32_16x16x32_bf16 v[60:63], v[104:107], v[220:223], v[60:63]
  s_waitcnt lgkmcnt(6)
  v_mfma_f32_16x16x32_bf16 v[48:51], v[68:71], v[224:227], v[48:51]
  ds_read_b64_tr_b16 v[92:93], v12 offset:24576
  ds_read_b64_tr_b16 v[94:95], v12 offset:25088
  v_mfma_f32_16x16x32_bf16 v[52:55], v[68:71], v[228:231], v[52:55]
  ds_read_b64_tr_b16 v[96:97], v13 offset:24576
  s_waitcnt lgkmcnt(7)
  v_mfma_f32_16x16x32_bf16 v[56:59], v[72:75], v[224:227], v[56:59]
  ds_read_b64_tr_b16 v[98:99], v13 offset:25088
  v_mfma_f32_16x16x32_bf16 v[60:63], v[72:75], v[228:231], v[60:63]
  ds_read_b64_tr_b16 v[100:101], v12 offset:28672
  s_waitcnt lgkmcnt(7)
  v_mfma_f32_16x16x32_bf16 v[48:51], v[76:79], v[232:235], v[48:51]
  ds_read_b64_tr_b16 v[102:103], v12 offset:29184
  v_mfma_f32_16x16x32_bf16 v[52:55], v[76:79], v[236:239], v[52:55]
  ds_read_b64_tr_b16 v[104:105], v13 offset:28672
  s_waitcnt lgkmcnt(7)
  v_mfma_f32_16x16x32_bf16 v[56:59], v[80:83], v[232:235], v[56:59]
  ds_read_b64_tr_b16 v[106:107], v13 offset:29184
  v_mfma_f32_16x16x32_bf16 v[60:63], v[80:83], v[236:239], v[60:63]
  s_cmp_eq_u32 s42, 0
  s_cbranch_scc1 Lnomk_0
  ds_read_b128 v[128:131], v23 offset:0
  ds_read_b128 v[132:135], v23 offset:1024
  ds_read_b128 v[136:139], v23 offset:2048
  ds_read_b128 v[140:143], v23 offset:3072
  ds_read_b128 v[144:147], v23 offset:4096
  ds_read_b128 v[148:151], v23 offset:5120
Lnomk_0:
  s_waitcnt lgkmcnt(0)
  s_barrier
  s_cmp_eq_u32 s95, 0
  s_cbranch_scc1 Lnohq_0
  s_waitcnt vmcnt(0)
  v_readfirstlane_b32 s58, v0
  s_nop 0
  s_cmp_eq_u32 s58, s49
  s_cselect_b32 s95, 0, s95
  s_cbranch_scc1 Lnohq_0
  buffer_load_dword v0, v20, s[28:31], s95 offen sc1
Lnohq_0:
  v_mfma_f32_16x16x32_bf16 v[48:51], v[92:95], v[240:243], v[48:51]
  v_mfma_f32_16x16x32_bf16 v[52:55], v[92:95], v[244:247], v[52:55]
  v_mfma_f32_16x16x32_bf16 v[56:59], v[96:99], v[240:243], v[56:59]
  v_mfma_f32_16x16x32_bf16 v[60:63], v[96:99], v[244:247], v[60:63]
  v_mfma_f32_16x16x32_bf16 v[48:51], v[100:103], v[248:251], v[48:51]
  v_mfma_f32_16x16x32_bf16 v[52:55], v[100:103], v[252:255], v[52:55]
  v_mfma_f32_16x16x32_bf16 v[56:59], v[104:107], v[248:251], v[56:59]
  v_mfma_f32_16x16x32_bf16 v[60:63], v[104:107], v[252:255], v[60:63]
  s_branch LPdone
LV1:
  s_setprio 1
  s_waitcnt lgkmcnt(7)
  v_mfma_f32_16x16x32_bf16 v[32:35], v[68:71], v[128:131], 0
  ds_read_b128 v[136:139], v8 offset:0
  ds_read_b64_tr_b16 v[92:93], v12 offset:4096
  s_waitcnt lgkmcnt(8)
  v_mfma_f32_16x16x32_bf16 v[36:39], v[68:71], v[132:135], 0
  ds_read_b64_tr_b16 v[94:95], v12 offset:4608
  ds_read_b128 v[140:143], v8 offset:2048
  s_add_u32 s60, s54, 2
  s_and_b32 s60, s60, 7
  s_lshl_b32 s60, s60, 7
  s_add_u32 m0, s52, 32768
  s_add_u32 s60, s60, s50
  buffer_load_dwordx4 v3, s[16:19], s60 offen lds
  s_sub_u32 m0, m0, 4096
  s_sub_u32 s60, s60, 32768
  buffer_load_dwordx4 v3, s[16:19], s60 offen lds
  s_waitcnt lgkmcnt(8)
  v_mfma_f32_16x16x32_bf16 v[40:43], v[72:75], v[128:131], 0
  ds_read_b64_tr_b16 v[96:97], v13 offset:4096
  ds_read_b64_tr_b16 v[98:99], v13 offset:4608
  v_mfma_f32_16x16x32_bf16 v[44:47], v[72:75], v[132:135], 0
  ds_read_b64_tr_b16 v[100:101], v12 offset:12288
  s_add_u32 s55, s54, 2
  s_and_b32 s55, s55, 7
  s_mul_i32 s55, s55, 196608
  s_add_u32 m0, s52, 98304
  s_add_u32 s55, s55, s51
  buffer_load_dwordx4 v6, s[20:23], s55 offen lds
  s_sub_u32 m0, m0, 4096
  s_sub_u32 s60, s55, 98304
  buffer_load_dwordx4 v6, s[20:23], s60 offen lds
  s_waitcnt lgkmcnt(9)
  v_mfma_f32_16x16x32_bf16 v[48:51], v[128:131], v[76:79], 0
  ds_read_b64_tr_b16 v[102:103], v12 offset:12800
  v_mfma_f32_16x16x32_bf16 v[52:55], v[132:135], v[76:79], 0
  ds_read_b64_tr_b16 v[104:105], v13 offset:12288
  s_add_u32 s60, s54, 2
  s_and_b32 s60, s60, 7
  s_lshl_b32 s60, s60, 7
  s_add_u32 m0, s52, 40960
  s_add_u32 s60, s60, s50
  s_add_u32 s60, s60, 65536
  buffer_load_dwordx4 v3, s[16:19], s60 offen lds
  s_sub_u32 m0, m0, 4096
  s_sub_u32 s60, s60, 32768
  buffer_load_dwordx4 v3, s[16:19], s60 offen lds
  s_waitcnt lgkmcnt(9)
  v_mfma_f32_16x16x32_bf16 v[56:59], v[128:131], v[80:83], 0
  ds_read_b64_tr_b16 v[106:107], v13 offset:12800
  v_mfma_f32_16x16x32_bf16 v[60:63], v[132:135], v[80:83], 0
  s_add_u32 m0, s52, 106496
  s_add_u32 s60, s55, 1024
  buffer_load_dwordx4 v6, s[20:23], s60 offen lds
  s_sub_u32 m0, m0, 4096
  s_sub_u32 s60, s60, 98304
  buffer_load_dwordx4 v6, s[20:23], s60 offen lds
  s_waitcnt vmcnt(8)
  s_barrier
  s_waitcnt lgkmcnt(7)
  v_mfma_f32_16x16x32_bf16 v[32:35], v[92:95], v[136:139], v[32:35]
  ds_read_b128 v[144:147], v7 offset:16384
  ds_read_b64_tr_b16 v[68:69], v12 offset:16384
  s_waitcnt lgkmcnt(8)
  v_mfma_f32_16x16x32_bf16 v[36:39], v[92:95], v[140:143], v[36:39]
  ds_read_b64_tr_b16 v[70:71], v12 offset:16896
  ds_read_b128 v[148:151], v7 offset:18432
  s_add_u32 s60, s54, 3
  s_and_b32 s60, s60, 7
  s_lshl_b32 s60, s60, 7
  s_add_u32 m0, s52, 49152
  s_add_u32 s60, s60, s50
  buffer_load_dwordx4 v3, s[16:19], s60 offen lds
  s_sub_u32 m0, m0, 4096
  s_sub_u32 s60, s60, 32768
  buffer_load_dwordx4 v3, s[16:19], s60 offen lds
  s_waitcnt lgkmcnt(8)
  v_mfma_f32_16x16x32_bf16 v[40:43], v[96:99], v[136:139], v[40:43]
  ds_read_b64_tr_b16 v[72:73], v13 offset:16384
  ds_read_b64_tr_b16 v[74:75], v13 offset:16896
  v_mfma_f32_16x16x32_bf16 v[44:47], v[96:99], v[140:143], v[44:47]
  ds_read_b64_tr_b16 v[76:77], v12 offset:24576
  s_add_u32 s55, s54, 3
  s_and_b32 s55, s55, 7
  s_mul_i32 s55, s55, 196608
  s_add_u32 m0, s52, 114688
  s_add_u32 s55, s55, s51
  buffer_load_dwordx4 v6, s[20:23], s55 offen lds
  s_sub_u32 m0, m0, 4096
  s_sub_u32 s60, s55, 98304
  buffer_load_dwordx4 v6, s[20:23], s60 offen lds
  s_waitcnt lgkmcnt(9)
  v_mfma_f32_16x16x32_bf16 v[48:51], v[136:139], v[100:103], v[48:51]
  ds_read_b64_tr_b16 v[78:79], v12 offset:25088
  v_mfma_f32_16x16x32_bf16 v[52:55], v[140:143], v[100:103], v[52:55]
  ds_read_b64_tr_b16 v[80:81], v13 offset:24576
  s_add_u32 s60, s54, 3
  s_and_b32 s60, s60, 7
  s_lshl_b32 s60, s60, 7
  s_add_u32 m0, s52, 57344
  s_add_u32 s60, s60, s50
  s_add_u32 s60, s60, 65536
  buffer_load_dwordx4 v3, s[16:19], s60 offen lds
  s_sub_u32 m0, m0, 4096
  s_sub_u32 s60, s60, 32768
  buffer_load_dwordx4 v3, s[16:19], s60 offen lds
  s_waitcnt lgkmcnt(9)
  v_mfma_f32_16x16x32_bf16 v[56:59], v[136:139], v[104:107], v[56:59]
  ds_read_b64_tr_b16 v[82:83], v13 offset:25088
  v_mfma_f32_16x16x32_bf16 v[60:63], v[140:143], v[104:107], v[60:63]
  s_add_u32 m0, s52, 122880
  s_add_u32 s60, s55, 1024
  buffer_load_dwordx4 v6, s[20:23], s60 offen lds
  s_sub_u32 m0, m0, 4096
  s_sub_u32 s60, s60, 98304
  buffer_load_dwordx4 v6, s[20:23], s60 offen lds
  s_waitcnt lgkmcnt(7)
  v_mfma_f32_16x16x32_bf16 v[32:35], v[68:71], v[144:147], v[32:35]
  ds_read_b128 v[152:155], v8 offset:16384
  ds_read_b64_tr_b16 v[92:93], v12 offset:20480
  s_waitcnt lgkmcnt(8)
  v_mfma_f32_16x16x32_bf16 v[36:39], v[68:71], v[148:151], v[36:39]
  ds_read_b64_tr_b16 v[94:95], v12 offset:20992
  ds_read_b128 v[156:159], v8 offset:18432
  s_waitcnt lgkmcnt(8)
  v_mfma_f32_16x16x32_bf16 v[40:43], v[72:75], v[144:147], v[40:43]
  ds_read_b64_tr_b16 v[96:97], v13 offset:20480
  ds_read_b64_tr_b16 v[98:99], v13 offset:20992
  v_mfma_f32_16x16x32_bf16 v[44:47], v[72:75], v[148:151], v[44:47]
  ds_read_b64_tr_b16 v[100:101], v12 offset:28672
  s_waitcnt lgkmcnt(9)
  v_mfma_f32_16x16x32_bf16 v[48:51], v[144:147], v[76:79], v[48:51]
  ds_read_b64_tr_b16 v[102:103], v12 offset:29184
  v_mfma_f32_16x16x32_bf16 v[52:55], v[148:151], v[76:79], v[52:55]
  ds_read_b64_tr_b16 v[104:105], v13 offset:28672
  s_waitcnt lgkmcnt(9)
  v_mfma_f32_16x16x32_bf16 v[56:59], v[144:147], v[80:83], v[56:59]
  ds_read_b64_tr_b16 v[106:107], v13 offset:29184
  v_mfma_f32_16x16x32_bf16 v[60:63], v[148:151], v[80:83], v[60:63]
  s_waitcnt vmcnt(8)
  s_barrier
  s_waitcnt lgkmcnt(7)
  v_mfma_f32_16x16x32_bf16 v[32:35], v[92:95], v[152:155], v[32:35]
  ds_read_b128 v[160:163], v7 offset:32768
  ds_read_b64_tr_b16 v[68:69], v12 offset:32768
  s_waitcnt lgkmcnt(8)
  v_mfma_f32_16x16x32_bf16 v[36:39], v[92:95], v[156:159], v[36:39]
  ds_read_b64_tr_b16 v[70:71], v12 offset:33280
  ds_read_b128 v[164:167], v7 offset:34816
  s_add_u32 s60, s54, 4
  s_and_b32 s60, s60, 7
  s_lshl_b32 s60, s60, 7
  s_add_u32 m0, s52, 0
  s_add_u32 s60, s60, s50
  buffer_load_dwordx4 v3, s[16:19], s60 offen lds
  s_sub_u32 m0, m0, 4096
  s_sub_u32 s60, s60, 32768
  buffer_load_dwordx4 v3, s[16:19], s60 offen lds
  s_waitcnt lgkmcnt(8)
  v_mfma_f32_16x16x32_bf16 v[40:43], v[96:99], v[152:155], v[40:43]
  ds_read_b64_tr_b16 v[72:73], v13 offset:32768
  ds_read_b64_tr_b16 v[74:75], v13 offset:33280
  v_mfma_f32_16x16x32_bf16 v[44:47], v[96:99], v[156:159], v[44:47]
  ds_read_b64_tr_b16 v[76:77], v12 offset:40960
  s_add_u32 s55, s54, 4
  s_and_b32 s55, s55, 7
  s_mul_i32 s55, s55, 196608
  s_add_u32 m0, s52, 65536
  s_add_u32 s55, s55, s51
  buffer_load_dwordx4 v6, s[20:23], s55 offen lds
  s_sub_u32 m0, m0, 4096
  s_sub_u32 s60, s55, 98304
  buffer_load_dwordx4 v6, s[20:23], s60 offen lds
  s_waitcnt lgkmcnt(9)
  v_mfma_f32_16x16x32_bf16 v[48:51], v[152:155], v[100:103], v[48:51]
  ds_read_b64_tr_b16 v[78:79], v12 offset:41472
  v_mfma_f32_16x16x32_bf16 v[52:55], v[156:159], v[100:103], v[52:55]
  ds_read_b64_tr_b16 v[80:81], v13 offset:40960
  s_add_u32 s60, s54, 4
  s_and_b32 s60, s60, 7
  s_lshl_b32 s60, s60, 7
  s_add_u32 m0, s52, 8192
  s_add_u32 s60, s60, s50
  s_add_u32 s60, s60, 65536
  buffer_load_dwordx4 v3, s[16:19], s60 offen lds
  s_sub_u32 m0, m0, 4096
  s_sub_u32 s60, s60, 32768
  buffer_load_dwordx4 v3, s[16:19], s60 offen lds
  s_waitcnt lgkmcnt(9)
  v_mfma_f32_16x16x32_bf16 v[56:59], v[152:155], v[104:107], v[56:59]
  ds_read_b64_tr_b16 v[82:83], v13 offset:41472
  v_mfma_f32_16x16x32_bf16 v[60:63], v[156:159], v[104:107], v[60:63]
  s_add_u32 m0, s52, 73728
  s_add_u32 s60, s55, 1024
  buffer_load_dwordx4 v6, s[20:23], s60 offen lds
  s_sub_u32 m0, m0, 4096
  s_sub_u32 s60, s60, 98304
  buffer_load_dwordx4 v6, s[20:23], s60 offen lds
  s_waitcnt lgkmcnt(7)
  v_mfma_f32_16x16x32_bf16 v[32:35], v[68:71], v[160:163], v[32:35]
  ds_read_b128 v[168:171], v8 offset:32768
  ds_read_b64_tr_b16 v[92:93], v12 offset:36864
  s_waitcnt lgkmcnt(8)
  v_mfma_f32_16x16x32_bf16 v[36:39], v[68:71], v[164:167], v[36:39]
  ds_read_b64_tr_b16 v[94:95], v12 offset:37376
  ds_read_b128 v[172:175], v8 offset:34816
  s_waitcnt lgkmcnt(8)
  v_mfma_f32_16x16x32_bf16 v[40:43], v[72:75], v[160:163], v[40:43]
  ds_read_b64_tr_b16 v[96:97], v13 offset:36864
  ds_read_b64_tr_b16 v[98:99], v13 offset:37376
  v_mfma_f32_16x16x32_bf16 v[44:47], v[72:75], v[164:167], v[44:47]
  ds_read_b64_tr_b16 v[100:101], v12 offset:45056
  s_waitcnt lgkmcnt(9)
  v_mfma_f32_16x16x32_bf16 v[48:51], v[160:163], v[76:79], v[48:51]
  ds_read_b64_tr_b16 v[102:103], v12 offset:45568
  v_mfma_f32_16x16x32_bf16 v[52:55], v[164:167], v[76:79], v[52:55]
  ds_read_b64_tr_b16 v[104:105], v13 offset:45056
  s_waitcnt lgkmcnt(9)
  v_mfma_f32_16x16x32_bf16 v[56:59], v[160:163], v[80:83], v[56:59]
  ds_read_b64_tr_b16 v[106:107], v13 offset:45568
  v_mfma_f32_16x16x32_bf16 v[60:63], v[164:167], v[80:83], v[60:63]
  s_waitcnt vmcnt(8)
  s_barrier
  s_add_u32 s56, s7, 65536
  buffer_store_dwordx4 v[64:67], v2, s[28:31], s7 offen sc1
  buffer_store_dwordx4 v[64:67], v2, s[28:31], s56 offen sc1
  s_waitcnt lgkmcnt(7)
  v_mfma_f32_16x16x32_bf16 v[32:35], v[92:95], v[168:171], v[32:35]
  ds_read_b128 v[176:179], v7 offset:49152
  ds_read_b64_tr_b16 v[68:69], v12 offset:49152
  s_waitcnt lgkmcnt(8)
  v_mfma_f32_16x16x32_bf16 v[36:39], v[92:95], v[172:175], v[36:39]
  ds_read_b64_tr_b16 v[70:71], v12 offset:49664
  ds_read_b128 v[180:183], v7 offset:51200
  s_add_u32 s60, s54, 5
  s_and_b32 s60, s60, 7
  s_lshl_b32 s60, s60, 7
  s_add_u32 m0, s52, 16384
  s_add_u32 s60, s60, s50
  buffer_load_dwordx4 v3, s[16:19], s60 offen lds
  s_sub_u32 m0, m0, 4096
  s_sub_u32 s60, s60, 32768
  buffer_load_dwordx4 v3, s[16:19], s60 offen lds
  s_waitcnt lgkmcnt(8)
  v_mfma_f32_16x16x32_bf16 v[40:43], v[96:99], v[168:171], v[40:43]
  ds_read_b64_tr_b16 v[72:73], v13 offset:49152
  ds_read_b64_tr_b16 v[74:75], v13 offset:49664
  v_mfma_f32_16x16x32_bf16 v[44:47], v[96:99], v[172:175], v[44:47]
  ds_read_b64_tr_b16 v[76:77], v12 offset:57344
  s_add_u32 s55, s54, 5
  s_and_b32 s55, s55, 7
  s_mul_i32 s55, s55, 196608
  s_add_u32 m0, s52, 81920
  s_add_u32 s55, s55, s51
  buffer_load_dwordx4 v6, s[20:23], s55 offen lds
  s_sub_u32 m0, m0, 4096
  s_sub_u32 s60, s55, 98304
  buffer_load_dwordx4 v6, s[20:23], s60 offen lds
  s_waitcnt lgkmcnt(9)
  v_mfma_f32_16x16x32_bf16 v[48:51], v[168:171], v[100:103], v[48:51]
  ds_read_b64_tr_b16 v[78:79], v12 offset:57856
  v_mfma_f32_16x16x32_bf16 v[52:55], v[172:175], v[100:103], v[52:55]
  ds_read_b64_tr_b16 v[80:81], v13 offset:57344
  s_add_u32 s60, s54, 5
  s_and_b32 s60, s60, 7
  s_lshl_b32 s60, s60, 7
  s_add_u32 m0, s52, 24576
  s_add_u32 s60, s60, s50
  s_add_u32 s60, s60, 65536
  buffer_load_dwordx4 v3, s[16:19], s60 offen lds
  s_sub_u32 m0, m0, 4096
  s_sub_u32 s60, s60, 32768
  buffer_load_dwordx4 v3, s[16:19], s60 offen lds
  s_waitcnt lgkmcnt(9)
  v_mfma_f32_16x16x32_bf16 v[56:59], v[168:171], v[104:107], v[56:59]
  ds_read_b64_tr_b16 v[82:83], v13 offset:57856
  v_mfma_f32_16x16x32_bf16 v[60:63], v[172:175], v[104:107], v[60:63]
  s_add_u32 m0, s52, 90112
  s_add_u32 s60, s55, 1024
  buffer_load_dwordx4 v6, s[20:23], s60 offen lds
  s_sub_u32 m0, m0, 4096
  s_sub_u32 s60, s60, 98304
  buffer_load_dwordx4 v6, s[20:23], s60 offen lds
  s_waitcnt lgkmcnt(7)
  v_mfma_f32_16x16x32_bf16 v[32:35], v[68:71], v[176:179], v[32:35]
  ds_read_b128 v[184:187], v8 offset:49152
  ds_read_b64_tr_b16 v[92:93], v12 offset:53248
  s_waitcnt lgkmcnt(8)
  v_mfma_f32_16x16x32_bf16 v[36:39], v[68:71], v[180:183], v[36:39]
  ds_read_b64_tr_b16 v[94:95], v12 offset:53760
  ds_read_b128 v[188:191], v8 offset:51200
  s_waitcnt lgkmcnt(8)
  v_mfma_f32_16x16x32_bf16 v[40:43], v[72:75], v[176:179], v[40:43]
  ds_read_b64_tr_b16 v[96:97], v13 offset:53248
  ds_read_b64_tr_b16 v[98:99], v13 offset:53760
  v_mfma_f32_16x16x32_bf16 v[44:47], v[72:75], v[180:183], v[44:47]
  ds_read_b64_tr_b16 v[100:101], v12 offset:61440
  s_waitcnt lgkmcnt(9)
  v_mfma_f32_16x16x32_bf16 v[48:51], v[176:179], v[76:79], v[48:51]
  ds_read_b64_tr_b16 v[102:103], v12 offset:61952
  v_mfma_f32_16x16x32_bf16 v[52:55], v[180:183], v[76:79], v[52:55]
  ds_read_b64_tr_b16 v[104:105], v13 offset:61440
  s_waitcnt lgkmcnt(9)
  v_mfma_f32_16x16x32_bf16 v[56:59], v[176:179], v[80:83], v[56:59]
  ds_read_b64_tr_b16 v[106:107], v13 offset:61952
  v_mfma_f32_16x16x32_bf16 v[60:63], v[180:183], v[80:83], v[60:63]
  s_waitcnt vmcnt(10)
  s_barrier
  s_waitcnt lgkmcnt(7)
  v_mfma_f32_16x16x32_bf16 v[32:35], v[92:95], v[184:187], v[32:35]
  ds_read_b128 v[192:195], v7 offset:0
  ds_read_b64_tr_b16 v[68:69], v12 offset:0
  s_waitcnt lgkmcnt(8)
  v_mfma_f32_16x16x32_bf16 v[36:39], v[92:95], v[188:191], v[36:39]
  ds_read_b64_tr_b16 v[70:71], v12 offset:512
  ds_read_b128 v[196:199], v7 offset:2048
  s_add_u32 s60, s54, 6
  s_and_b32 s60, s60, 7
  s_lshl_b32 s60, s60, 7
  s_add_u32 m0, s52, 32768
  s_add_u32 s60, s60, s50
  buffer_load_dwordx4 v3, s[16:19], s60 offen lds
  s_sub_u32 m0, m0, 4096
  s_sub_u32 s60, s60, 32768
  buffer_load_dwordx4 v3, s[16:19], s60 offen lds
  s_waitcnt lgkmcnt(8)
  v_mfma_f32_16x16x32_bf16 v[40:43], v[96:99], v[184:187], v[40:43]
  ds_read_b64_tr_b16 v[72:73], v13 offset:0
  ds_read_b64_tr_b16 v[74:75], v13 offset:512
  v_mfma_f32_16x16x32_bf16 v[44:47], v[96:99], v[188:191], v[44:47]
  ds_read_b64_tr_b16 v[76:77], v12 offset:8192
  s_add_u32 s55, s54, 6
  s_and_b32 s55, s55, 7
  s_mul_i32 s55, s55, 196608
  s_add_u32 m0, s52, 98304
  s_add_u32 s55, s55, s51
  buffer_load_dwordx4 v6, s[20:23], s55 offen lds
  s_sub_u32 m0, m0, 4096
  s_sub_u32 s60, s55, 98304
  buffer_load_dwordx4 v6, s[20:23], s60 offen lds
  s_waitcnt lgkmcnt(9)
  v_mfma_f32_16x16x32_bf16 v[48:51], v[184:187], v[100:103], v[48:51]
  ds_read_b64_tr_b16 v[78:79], v12 offset:8704
  v_mfma_f32_16x16x32_bf16 v[52:55], v[188:191], v[100:103], v[52:55]
  ds_read_b64_tr_b16 v[80:81], v13 offset:8192
  s_add_u32 s60, s54, 6
  s_and_b32 s60, s60, 7
  s_lshl_b32 s60, s60, 7
  s_add_u32 m0, s52, 40960
  s_add_u32 s60, s60, s50
  s_add_u32 s60, s60, 65536
  buffer_load_dwordx4 v3, s[16:19], s60 offen lds
  s_sub_u32 m0, m0, 4096
  s_sub_u32 s60, s60, 32768
  buffer_load_dwordx4 v3, s[16:19], s60 offen lds
  s_waitcnt lgkmcnt(9)
  v_mfma_f32_16x16x32_bf16 v[56:59], v[184:187], v[104:107], v[56:59]
  ds_read_b64_tr_b16 v[82:83], v13 offset:8704
  v_mfma_f32_16x16x32_bf16 v[60:63], v[188:191], v[104:107], v[60:63]
  s_add_u32 m0, s52, 106496
  s_add_u32 s60, s55, 1024
  buffer_load_dwordx4 v6, s[20:23], s60 offen lds
  s_sub_u32 m0, m0, 4096
  s_sub_u32 s60, s60, 98304
  buffer_load_dwordx4 v6, s[20:23], s60 offen lds
  s_waitcnt lgkmcnt(7)
  v_mfma_f32_16x16x32_bf16 v[32:35], v[68:71], v[192:195], v[32:35]
  ds_read_b128 v[200:203], v8 offset:0
  ds_read_b64_tr_b16 v[92:93], v12 offset:4096
  s_waitcnt lgkmcnt(8)
  v_mfma_f32_16x16x32_bf16 v[36:39], v[68:71], v[196:199], v[36:39]
  ds_read_b64_tr_b16 v[94:95], v12 offset:4608
  ds_read_b128 v[204:207], v8 offset:2048
  s_waitcnt lgkmcnt(8)
  v_mfma_f32_16x16x32_bf16 v[40:43], v[72:75], v[192:195], v[40:43]
  ds_read_b64_tr_b16 v[96:97], v13 offset:4096
  ds_read_b64_tr_b16 v[98:99], v13 offset:4608
  v_mfma_f32_16x16x32_bf16 v[44:47], v[72:75], v[196:199], v[44:47]
  ds_read_b64_tr_b16 v[100:101], v12 offset:12288
  s_waitcnt lgkmcnt(9)
  v_mfma_f32_16x16x32_bf16 v[48:51], v[192:195], v[76:79], v[48:51]
  ds_read_b64_tr_b16 v[102:103], v12 offset:12800
  v_mfma_f32_16x16x32_bf16 v[52:55], v[196:199], v[76:79], v[52:55]
  ds_read_b64_tr_b16 v[104:105], v13 offset:12288
  s_waitcnt lgkmcnt(9)
  v_mfma_f32_16x16x32_bf16 v[56:59], v[192:195], v[80:83], v[56:59]
  ds_read_b64_tr_b16 v[106:107], v13 offset:12800
  v_mfma_f32_16x16x32_bf16 v[60:63], v[196:199], v[80:83], v[60:63]
  s_waitcnt vmcnt(8)
  s_barrier
  s_waitcnt lgkmcnt(7)
  v_mfma_f32_16x16x32_bf16 v[32:35], v[92:95], v[200:203], v[32:35]
  ds_read_b128 v[208:211], v7 offset:16384
  ds_read_b64_tr_b16 v[68:69], v12 offset:16384
  s_waitcnt lgkmcnt(8)
  v_mfma_f32_16x16x32_bf16 v[36:39], v[92:95], v[204:207], v[36:39]
  ds_read_b64_tr_b16 v[70:71], v12 offset:16896
  ds_read_b128 v[212:215], v7 offset:18432
  s_add_u32 s60, s54, 7
  s_and_b32 s60, s60, 7
  s_lshl_b32 s60, s60, 7
  s_add_u32 m0, s52, 49152
  s_add_u32 s60, s60, s50
  buffer_load_dwordx4 v3, s[16:19], s60 offen lds
  s_sub_u32 m0, m0, 4096
  s_sub_u32 s60, s60, 32768
  buffer_load_dwordx4 v3, s[16:19], s60 offen lds
  s_waitcnt lgkmcnt(8)
  v_mfma_f32_16x16x32_bf16 v[40:43], v[96:99], v[200:203], v[40:43]
  ds_read_b64_tr_b16 v[72:73], v13 offset:16384
  ds_read_b64_tr_b16 v[74:75], v13 offset:16896
  v_mfma_f32_16x16x32_bf16 v[44:47], v[96:99], v[204:207], v[44:47]
  ds_read_b64_tr_b16 v[76:77], v12 offset:24576
  s_add_u32 s55, s54, 7
  s_and_b32 s55, s55, 7
  s_mul_i32 s55, s55, 196608
  s_add_u32 m0, s52, 114688
  s_add_u32 s55, s55, s51
  buffer_load_dwordx4 v6, s[20:23], s55 offen lds
  s_sub_u32 m0, m0, 4096
  s_sub_u32 s60, s55, 98304
  buffer_load_dwordx4 v6, s[20:23], s60 offen lds
  s_waitcnt lgkmcnt(9)
  v_mfma_f32_16x16x32_bf16 v[48:51], v[200:203], v[100:103], v[48:51]
  ds_read_b64_tr_b16 v[78:79], v12 offset:25088
  v_mfma_f32_16x16x32_bf16 v[52:55], v[204:207], v[100:103], v[52:55]
  ds_read_b64_tr_b16 v[80:81], v13 offset:24576
  s_add_u32 s60, s54, 7
  s_and_b32 s60, s60, 7
  s_lshl_b32 s60, s60, 7
  s_add_u32 m0, s52, 57344
  s_add_u32 s60, s60, s50
  s_add_u32 s60, s60, 65536
  buffer_load_dwordx4 v3, s[16:19], s60 offen lds
  s_sub_u32 m0, m0, 4096
  s_sub_u32 s60, s60, 32768
  buffer_load_dwordx4 v3, s[16:19], s60 offen lds
  s_waitcnt lgkmcnt(9)
  v_mfma_f32_16x16x32_bf16 v[56:59], v[200:203], v[104:107], v[56:59]
  ds_read_b64_tr_b16 v[82:83], v13 offset:25088
  v_mfma_f32_16x16x32_bf16 v[60:63], v[204:207], v[104:107], v[60:63]
  s_add_u32 m0, s52, 122880
  s_add_u32 s60, s55, 1024
  buffer_load_dwordx4 v6, s[20:23], s60 offen lds
  s_sub_u32 m0, m0, 4096
  s_sub_u32 s60, s60, 98304
  buffer_load_dwordx4 v6, s[20:23], s60 offen lds
  s_waitcnt lgkmcnt(7)
  v_mfma_f32_16x16x32_bf16 v[32:35], v[68:71], v[208:211], v[32:35]
  ds_read_b128 v[216:219], v8 offset:16384
  ds_read_b64_tr_b16 v[92:93], v12 offset:20480
  s_waitcnt lgkmcnt(8)
  v_mfma_f32_16x16x32_bf16 v[36:39], v[68:71], v[212:215], v[36:39]
  ds_read_b64_tr_b16 v[94:95], v12 offset:20992
  ds_read_b128 v[220:223], v8 offset:18432
  s_waitcnt lgkmcnt(8)
  v_mfma_f32_16x16x32_bf16 v[40:43], v[72:75], v[208:211], v[40:43]
  ds_read_b64_tr_b16 v[96:97], v13 offset:20480
  ds_read_b64_tr_b16 v[98:99], v13 offset:20992
  v_mfma_f32_16x16x32_bf16 v[44:47], v[72:75], v[212:215], v[44:47]
  ds_read_b64_tr_b16 v[100:101], v12 offset:28672
  s_waitcnt lgkmcnt(9)
  v_mfma_f32_16x16x32_bf16 v[48:51], v[208:211], v[76:79], v[48:51]
  ds_read_b64_tr_b16 v[102:103], v12 offset:29184
  v_mfma_f32_16x16x32_bf16 v[52:55], v[212:215], v[76:79], v[52:55]
  ds_read_b64_tr_b16 v[104:105], v13 offset:28672
  s_waitcnt lgkmcnt(9)
  v_mfma_f32_16x16x32_bf16 v[56:59], v[208:211], v[80:83], v[56:59]
  ds_read_b64_tr_b16 v[106:107], v13 offset:29184
  v_mfma_f32_16x16x32_bf16 v[60:63], v[212:215], v[80:83], v[60:63]
  s_waitcnt vmcnt(8)
  s_barrier
  s_waitcnt lgkmcnt(7)
  v_mfma_f32_16x16x32_bf16 v[32:35], v[92:95], v[216:219], v[32:35]
  ds_read_b128 v[224:227], v7 offset:32768
  ds_read_b64_tr_b16 v[68:69], v12 offset:32768
  s_waitcnt lgkmcnt(8)
  v_mfma_f32_16x16x32_bf16 v[36:39], v[92:95], v[220:223], v[36:39]
  ds_read_b64_tr_b16 v[70:71], v12 offset:33280
  ds_read_b128 v[228:231], v7 offset:34816
  s_add_u32 s60, s54, 0
  s_and_b32 s60, s60, 7
  s_mul_i32 s60, s60, 196608
  s_add_u32 m0, s52, 0
  s_add_u32 s60, s60, s4
  buffer_load_dwordx4 v6, s[20:23], s60 offen lds
  s_sub_u32 m0, m0, 4096
  s_sub_u32 s60, s60, 98304
  buffer_load_dwordx4 v6, s[20:23], s60 offen lds
  s_waitcnt lgkmcnt(8)
  v_mfma_f32_16x16x32_bf16 v[40:43], v[96:99], v[216:219], v[40:43]
  ds_read_b64_tr_b16 v[72:73], v13 offset:32768
  ds_read_b64_tr_b16 v[74:75], v13 offset:33280
  v_mfma_f32_16x16x32_bf16 v[44:47], v[96:99], v[220:223], v[44:47]
  ds_read_b64_tr_b16 v[76:77], v12 offset:40960
  s_add_u32 s60, s54, 1
  s_and_b32 s60, s60, 7
  s_mul_i32 s60, s60, 196608
  s_add_u32 m0, s52, 8192
  s_add_u32 s60, s60, s4
  buffer_load_dwordx4 v6, s[20:23], s60 offen lds
  s_sub_u32 m0, m0, 4096
  s_sub_u32 s60, s60, 98304
  buffer_load_dwordx4 v6, s[20:23], s60 offen lds
  s_waitcnt lgkmcnt(9)
  v_mfma_f32_16x16x32_bf16 v[48:51], v[216:219], v[100:103], v[48:51]
  ds_read_b64_tr_b16 v[78:79], v12 offset:41472
  v_mfma_f32_16x16x32_bf16 v[52:55], v[220:223], v[100:103], v[52:55]
  ds_read_b64_tr_b16 v[80:81], v13 offset:40960
  s_add_u32 s60, s54, 2
  s_and_b32 s60, s60, 7
  s_mul_i32 s60, s60, 196608
  s_add_u32 m0, s52, 65536
  s_add_u32 s60, s60, s4
  buffer_load_dwordx4 v6, s[20:23], s60 offen lds
  s_sub_u32 m0, m0, 4096
  s_sub_u32 s60, s60, 98304
  buffer_load_dwordx4 v6, s[20:23], s60 offen lds
  s_waitcnt lgkmcnt(9)
  v_mfma_f32_16x16x32_bf16 v[56:59], v[216:219], v[104:107], v[56:59]
  ds_read_b64_tr_b16 v[82:83], v13 offset:41472
  v_mfma_f32_16x16x32_bf16 v[60:63], v[220:223], v[104:107], v[60:63]
  s_add_u32 s60, s54, 3
  s_and_b32 s60, s60, 7
  s_mul_i32 s60, s60, 196608
  s_add_u32 m0, s52, 73728
  s_add_u32 s60, s60, s4
  buffer_load_dwordx4 v6, s[20:23], s60 offen lds
  s_sub_u32 m0, m0, 4096
  s_sub_u32 s60, s60, 98304
  buffer_load_dwordx4 v6, s[20:23], s60 offen lds
  s_waitcnt lgkmcnt(7)
  v_mfma_f32_16x16x32_bf16 v[32:35], v[68:71], v[224:227], v[32:35]
  ds_read_b128 v[232:235], v8 offset:32768
  ds_read_b64_tr_b16 v[92:93], v12 offset:36864
  s_waitcnt lgkmcnt(8)
  v_mfma_f32_16x16x32_bf16 v[36:39], v[68:71], v[228:231], v[36:39]
  ds_read_b64_tr_b16 v[94:95], v12 offset:37376
  ds_read_b128 v[236:239], v8 offset:34816
  s_waitcnt lgkmcnt(8)
  v_mfma_f32_16x16x32_bf16 v[40:43], v[72:75], v[224:227], v[40:43]
  ds_read_b64_tr_b16 v[96:97], v13 offset:36864
  ds_read_b64_tr_b16 v[98:99], v13 offset:37376
  v_mfma_f32_16x16x32_bf16 v[44:47], v[72:75], v[228:231], v[44:47]
  ds_read_b64_tr_b16 v[100:101], v12 offset:45056
  s_waitcnt lgkmcnt(9)
  v_mfma_f32_16x16x32_bf16 v[48:51], v[224:227], v[76:79], v[48:51]
  ds_read_b64_tr_b16 v[102:103], v12 offset:45568
  v_mfma_f32_16x16x32_bf16 v[52:55], v[228:231], v[76:79], v[52:55]
  ds_read_b64_tr_b16 v[104:105], v13 offset:45056
  s_waitcnt lgkmcnt(9)
  v_mfma_f32_16x16x32_bf16 v[56:59], v[224:227], v[80:83], v[56:59]
  ds_read_b64_tr_b16 v[106:107], v13 offset:45568
  v_mfma_f32_16x16x32_bf16 v[60:63], v[228:231], v[80:83], v[60:63]
  s_waitcnt vmcnt(8)
  s_barrier
  s_waitcnt lgkmcnt(7)
  v_mfma_f32_16x16x32_bf16 v[32:35], v[92:95], v[232:235], v[32:35]
  ds_read_b128 v[240:243], v7 offset:49152
  ds_read_b64_tr_b16 v[68:69], v12 offset:49152
  s_waitcnt lgkmcnt(8)
  v_mfma_f32_16x16x32_bf16 v[36:39], v[92:95], v[236:239], v[36:39]
  ds_read_b64_tr_b16 v[70:71], v12 offset:49664
  ds_read_b128 v[244:247], v7 offset:51200
  s_add_u32 s60, s54, 4
  s_and_b32 s60, s60, 7
  s_mul_i32 s60, s60, 196608
  s_add_u32 m0, s52, 16384
  s_add_u32 s60, s60, s4
  buffer_load_dwordx4 v6, s[20:23], s60 offen lds
  s_sub_u32 m0, m0, 4096
  s_sub_u32 s60, s60, 98304
  buffer_load_dwordx4 v6, s[20:23], s60 offen lds
  s_waitcnt lgkmcnt(8)
  v_mfma_f32_16x16x32_bf16 v[40:43], v[96:99], v[232:235], v[40:43]
  ds_read_b64_tr_b16 v[72:73], v13 offset:49152
  ds_read_b64_tr_b16 v[74:75], v13 offset:49664
  v_mfma_f32_16x16x32_bf16 v[44:47], v[96:99], v[236:239], v[44:47]
  ds_read_b64_tr_b16 v[76:77], v12 offset:57344
  s_add_u32 s60, s54, 5
  s_and_b32 s60, s60, 7
  s_mul_i32 s60, s60, 196608
  s_add_u32 m0, s52, 24576
  s_add_u32 s60, s60, s4
  buffer_load_dwordx4 v6, s[20:23], s60 offen lds
  s_sub_u32 m0, m0, 4096
  s_sub_u32 s60, s60, 98304
  buffer_load_dwordx4 v6, s[20:23], s60 offen lds
  s_waitcnt lgkmcnt(9)
  v_mfma_f32_16x16x32_bf16 v[48:51], v[232:235], v[100:103], v[48:51]
  ds_read_b64_tr_b16 v[78:79], v12 offset:57856
  v_mfma_f32_16x16x32_bf16 v[52:55], v[236:239], v[100:103], v[52:55]
  ds_read_b64_tr_b16 v[80:81], v13 offset:57344
  s_add_u32 s60, s54, 6
  s_and_b32 s60, s60, 7
  s_mul_i32 s60, s60, 196608
  s_add_u32 m0, s52, 81920
  s_add_u32 s60, s60, s4
  buffer_load_dwordx4 v6, s[20:23], s60 offen lds
  s_sub_u32 m0, m0, 4096
  s_sub_u32 s60, s60, 98304
  buffer_load_dwordx4 v6, s[20:23], s60 offen lds
  s_waitcnt lgkmcnt(9)
  v_mfma_f32_16x16x32_bf16 v[56:59], v[232:235], v[104:107], v[56:59]
  ds_read_b64_tr_b16 v[82:83], v13 offset:57856
  v_mfma_f32_16x16x32_bf16 v[60:63], v[236:239], v[104:107], v[60:63]
  s_add_u32 s60, s54, 7
  s_and_b32 s60, s60, 7
  s_mul_i32 s60, s60, 196608
  s_add_u32 m0, s52, 90112
  s_add_u32 s60, s60, s4
  buffer_load_dwordx4 v6, s[20:23], s60 offen lds
  s_sub_u32 m0, m0, 4096
  s_sub_u32 s60, s60, 98304
  buffer_load_dwordx4 v6, s[20:23], s60 offen lds
  s_waitcnt lgkmcnt(7)
  v_mfma_f32_16x16x32_bf16 v[32:35], v[68:71], v[240:243], v[32:35]
  ds_read_b128 v[248:251], v8 offset:49152
  ds_read_b64_tr_b16 v[92:93], v12 offset:53248
  s_waitcnt lgkmcnt(8)
  v_mfma_f32_16x16x32_bf16 v[36:39], v[68:71], v[244:247], v[36:39]
  ds_read_b64_tr_b16 v[94:95], v12 offset:53760
  ds_read_b128 v[252:255], v8 offset:51200
  s_waitcnt lgkmcnt(8)
  v_mfma_f32_16x16x32_bf16 v[40:43], v[72:75], v[240:243], v[40:43]
  ds_read_b64_tr_b16 v[96:97], v13 offset:53248
  ds_read_b64_tr_b16 v[98:99], v13 offset:53760
  v_mfma_f32_16x16x32_bf16 v[44:47], v[72:75], v[244:247], v[44:47]
  ds_read_b64_tr_b16 v[100:101], v12 offset:61440
  s_waitcnt lgkmcnt(9)
  v_mfma_f32_16x16x32_bf16 v[48:51], v[240:243], v[76:79], v[48:51]
  ds_read_b64_tr_b16 v[102:103], v12 offset:61952
  v_mfma_f32_16x16x32_bf16 v[52:55], v[244:247], v[76:79], v[52:55]
  ds_read_b64_tr_b16 v[104:105], v13 offset:61440
  s_waitcnt lgkmcnt(9)
  v_mfma_f32_16x16x32_bf16 v[56:59], v[240:243], v[80:83], v[56:59]
  ds_read_b64_tr_b16 v[106:107], v13 offset:61952
  v_mfma_f32_16x16x32_bf16 v[60:63], v[244:247], v[80:83], v[60:63]
  s_waitcnt lgkmcnt(7)
  v_mfma_f32_16x16x32_bf16 v[32:35], v[92:95], v[248:251], v[32:35]
  s_waitcnt lgkmcnt(6)
  v_mfma_f32_16x16x32_bf16 v[36:39], v[92:95], v[252:255], v[36:39]
  s_waitcnt lgkmcnt(4)
  v_mfma_f32_16x16x32_bf16 v[40:43], v[96:99], v[248:251], v[40:43]
  v_mfma_f32_16x16x32_bf16 v[44:47], v[96:99], v[252:255], v[44:47]
  s_waitcnt lgkmcnt(2)
  v_mfma_f32_16x16x32_bf16 v[48:51], v[248:251], v[100:103], v[48:51]
  v_mfma_f32_16x16x32_bf16 v[52:55], v[252:255], v[100:103], v[52:55]
  s_waitcnt lgkmcnt(0)
  v_mfma_f32_16x16x32_bf16 v[56:59], v[248:251], v[104:107], v[56:59]
  v_mfma_f32_16x16x32_bf16 v[60:63], v[252:255], v[104:107], v[60:63]
  s_nop 1
  v_cvt_pk_bf16_f32 v116, v32, v33
  v_cvt_pk_bf16_f32 v117, v34, v35
  v_cvt_pk_bf16_f32 v118, v36, v37
  v_cvt_pk_bf16_f32 v119, v38, v39
  v_cvt_pk_bf16_f32 v120, v40, v41
  v_cvt_pk_bf16_f32 v121, v42, v43
  v_cvt_pk_bf16_f32 v122, v44, v45
  v_cvt_pk_bf16_f32 v123, v46, v47
  v_permlane16_swap_b32 v116, v118
  v_permlane16_swap_b32 v117, v119
  buffer_store_dwordx4 v[116:119], v2, s[28:31], s6 offen sc1
  v_cvt_pk_bf16_f32 v124, v48, v49
  v_cvt_pk_bf16_f32 v125, v50, v51
  v_cvt_pk_bf16_f32 v126, v52, v53
  v_cvt_pk_bf16_f32 v127, v54, v55
  v_permlane16_swap_b32 v120, v122
  v_permlane16_swap_b32 v121, v123
  buffer_store_dwordx4 v[120:123], v2, s[28:31], s92 offen sc1
  v_cvt_pk_bf16_f32 v32, v56, v57
  v_cvt_pk_bf16_f32 v33, v58, v59
  v_cvt_pk_bf16_f32 v34, v60, v61
  v_cvt_pk_bf16_f32 v35, v62, v63
  v_permlane16_swap_b32 v124, v126
  v_permlane16_swap_b32 v125, v127
  buffer_store_dwordx4 v[124:127], v2, s[28:31], s6 offen offset:1024 sc1
  v_permlane16_swap_b32 v32, v34
  v_permlane16_swap_b32 v33, v35
  buffer_store_dwordx4 v[32:35], v2, s[28:31], s92 offen offset:1024 sc1
  s_cmp_eq_u32 s42, 0
  s_cbranch_scc1 Lnbp_1
  v_mov_b32 v44, 0x3f803f80
  s_mov_b32 vcc_lo, 0x00110011
  s_mov_b32 vcc_hi, 0x00110011
  v_cndmask_b32 v44, 0, v44, vcc
  v_mov_b32 v36, v44
  v_mov_b32 v37, v44
  v_mov_b32 v38, v44
  v_mov_b32 v39, v44
  v_mov_b32 v40, v44
  v_mov_b32 v41, v44
  v_mov_b32 v42, v44
  v_mov_b32 v43, v44
  s_mov_b32 vcc_lo, 0xffff0000
  s_mov_b32 vcc_hi, 0xffff0000
  v_permlane16_swap_b32 v124, v36
  v_permlane16_swap_b32 v125, v37
  v_permlane16_swap_b32 v126, v38
  v_permlane16_swap_b32 v127, v39
  v_permlane16_swap_b32 v32, v40
  v_permlane16_swap_b32 v33, v41
  v_permlane16_swap_b32 v34, v42
  v_permlane16_swap_b32 v35, v43
  v_cndmask_b32 v84, v36, v116, vcc
  v_cndmask_b32 v85, v37, v117, vcc
  v_cndmask_b32 v86, v38, v118, vcc
  v_cndmask_b32 v87, v39, v119, vcc
  ds_write_b128 v10, v[84:87] offset:4096
  v_cndmask_b32 v88, v40, v120, vcc
  v_cndmask_b32 v89, v41, v121, vcc
  v_cndmask_b32 v90, v42, v122, vcc
  v_cndmask_b32 v91, v43, v123, vcc
  ds_write_b128 v10, v[88:91] offset:5120
  s_waitcnt lgkmcnt(0)
Lnbp_1:
  buffer_store_dwordx4 v[84:87], v2, s[28:31], s0 offen sc1
  buffer_store_dwordx4 v[88:91], v2, s[28:31], s0 offen offset:1024 sc1
  buffer_load_dword v21, v20, s[32:35], 0 offen sc1
  s_waitcnt vmcnt(19)
  s_barrier
  ds_read_b64_tr_b16 v[68:69], v14 offset:0
  ds_read_b64_tr_b16 v[70:71], v14 offset:512
  ds_read_b64_tr_b16 v[72:73], v15 offset:0
  ds_read_b64_tr_b16 v[74:75], v15 offset:512
  ds_read_b64_tr_b16 v[76:77], v14 offset:4096
  ds_read_b64_tr_b16 v[78:79], v14 offset:4608
  ds_read_b64_tr_b16 v[80:81], v15 offset:4096
  ds_read_b64_tr_b16 v[82:83], v15 offset:4608
  s_waitcnt lgkmcnt(6)
  v_mfma_f32_16x16x32_bf16 v[48:51], v[68:71], v[128:131], 0
  ds_read_b64_tr_b16 v[92:93], v14 offset:8192
  ds_read_b64_tr_b16 v[94:95], v14 offset:8704
  v_mfma_f32_16x16x32_bf16 v[52:55], v[68:71], v[132:135], 0
  ds_read_b64_tr_b16 v[96:97], v15 offset:8192
  s_waitcnt lgkmcnt(7)
  v_mfma_f32_16x16x32_bf16 v[56:59], v[72:75], v[128:131], 0
  ds_read_b64_tr_b16 v[98:99], v15 offset:8704
  v_mfma_f32_16x16x32_bf16 v[60:63], v[72:75], v[132:135], 0
  ds_read_b64_tr_b16 v[100:101], v14 offset:12288
  s_waitcnt lgkmcnt(7)
  v_mfma_f32_16x16x32_bf16 v[48:51], v[76:79], v[136:139], v[48:51]
  ds_read_b64_tr_b16 v[102:103], v14 offset:12800
  v_mfma_f32_16x16x32_bf16 v[52:55], v[76:79], v[140:143], v[52:55]
  ds_read_b64_tr_b16 v[104:105], v15 offset:12288
  s_waitcnt lgkmcnt(7)
  v_mfma_f32_16x16x32_bf16 v[56:59], v[80:83], v[136:139], v[56:59]
  ds_read_b64_tr_b16 v[106:107], v15 offset:12800
  v_mfma_f32_16x16x32_bf16 v[60:63], v[80:83], v[140:143], v[60:63]
  s_waitcnt vmcnt(15)
  s_barrier
  s_and_b32 s56, s2, 7
  s_lshl_b32 s56, s56, 3
  s_bfe_u32 s57, s2, 0x30003
  s_add_u32 s56, s56, s57
  s_cmp_lt_u32 s56, 32
  s_cselect_b32 s24, s8, s12
  s_cselect_b32 s25, s9, s13
  s_mov_b32 s26, 512*1024
  s_mov_b32 s27, 0x20000
  s_lshl_b32 s57, s44, 3
  s_add_u32 s57, s57, s40
  s_lshl_b32 s58, s57, 6
  s_add_u32 s58, s58, s56
  s_lshl_b32 s58, s58, 10
  s_add_u32 s58, s58, 11534336
  s_and_b32 s56, s56, 31
  s_lshl_b32 s56, s56, 14
  s_lshl_b32 s57, s57, 6
  s_add_u32 s56, s56, s57
  s_cmp_eq_u32 s42, 0
  s_cselect_b32 s64, s58, s64
  s_cselect_b32 s6, s56, 0x7ff00000
  s_waitcnt lgkmcnt(6)
  v_mfma_f32_16x16x32_bf16 v[48:51], v[92:95], v[144:147], v[48:51]
  ds_read_b64_tr_b16 v[68:69], v12 offset:0
  ds_read_b64_tr_b16 v[70:71], v12 offset:512
  v_mov_b32 v64, 0x3f803f80
  v_mfma_f32_16x16x32_bf16 v[52:55], v[92:95], v[148:151], v[52:55]
  ds_read_b64_tr_b16 v[72:73], v13 offset:0
  s_mov_b32 vcc_lo, 0x55555555
  s_mov_b32 vcc_hi, 0x55555555
  v_cndmask_b32 v64, 0, v64, vcc
  s_waitcnt lgkmcnt(7)
  v_mfma_f32_16x16x32_bf16 v[56:59], v[96:99], v[144:147], v[56:59]
  ds_read_b64_tr_b16 v[74:75], v13 offset:512
  v_mov_b32 v65, v64
  v_mfma_f32_16x16x32_bf16 v[60:63], v[96:99], v[148:151], v[60:63]
  ds_read_b64_tr_b16 v[76:77], v12 offset:4096
  v_mov_b32 v66, v64
  s_waitcnt lgkmcnt(7)
  v_mfma_f32_16x16x32_bf16 v[48:51], v[100:103], v[152:155], v[48:51]
  ds_read_b64_tr_b16 v[78:79], v12 offset:4608
  v_mov_b32 v67, v64
  v_mfma_f32_16x16x32_bf16 v[52:55], v[100:103], v[156:159], v[52:55]
  ds_read_b64_tr_b16 v[80:81], v13 offset:4096
  v_lshrrev_b32 v7, 1, v1
  s_waitcnt lgkmcnt(7)
  v_mfma_f32_16x16x32_bf16 v[56:59], v[104:107], v[152:155], v[56:59]
  ds_read_b64_tr_b16 v[82:83], v13 offset:4608
  v_and_b32 v8, 1, v1
  v_mfma_f32_16x16x32_bf16 v[60:63], v[104:107], v[156:159], v[60:63]
  v_mul_u32_u24 v4, 16640, v7
  s_waitcnt lgkmcnt(6)
  v_mfma_f32_16x16x32_bf16 v[48:51], v[68:71], v[160:163], v[48:51]
  ds_read_b64_tr_b16 v[92:93], v12 offset:8192
  ds_read_b64_tr_b16 v[94:95], v12 offset:8704
  v_lshl_add_u32 v4, v8, 4, v4
  v_mfma_f32_16x16x32_bf16 v[52:55], v[68:71], v[164:167], v[52:55]
  ds_read_b64_tr_b16 v[96:97], v13 offset:8192
  v_add_u32 v4, s65, v4
  s_waitcnt lgkmcnt(7)
  v_mfma_f32_16x16x32_bf16 v[56:59], v[72:75], v[160:163], v[56:59]
  ds_read_b64_tr_b16 v[98:99], v13 offset:8704
  v_lshrrev_b32 v3, 5, v1
  v_mfma_f32_16x16x32_bf16 v[60:63], v[72:75], v[164:167], v[60:63]
  ds_read_b64_tr_b16 v[100:101], v12 offset:12288
  v_mov_b32 v7, v16
  s_waitcnt lgkmcnt(7)
  v_mfma_f32_16x16x32_bf16 v[48:51], v[76:79], v[168:171], v[48:51]
  ds_read_b64_tr_b16 v[102:103], v12 offset:12800
  v_mov_b32 v8, v17
  v_mfma_f32_16x16x32_bf16 v[52:55], v[76:79], v[172:175], v[52:55]
  ds_read_b64_tr_b16 v[104:105], v13 offset:12288
  ds_read_b128 v[84:87], v10 offset:0
  s_waitcnt lgkmcnt(8)
  v_mfma_f32_16x16x32_bf16 v[56:59], v[80:83], v[168:171], v[56:59]
  ds_read_b64_tr_b16 v[106:107], v13 offset:12800
  ds_read_b128 v[88:91], v10 offset:1024
  v_mfma_f32_16x16x32_bf16 v[60:63], v[80:83], v[172:175], v[60:63]
  s_waitcnt vmcnt(0)
  s_barrier
  s_mov_b32 s61, 0
Lnonce_1:
  v_readfirstlane_b32 s49, v21
  s_add_u32 s61, s61, 1
  s_cmp_lg_u32 s49, 0
  s_cbranch_scc1 Lnonce_1_ok
  s_cmp_gt_u32 s61, 262144
  s_cbranch_scc1 Lnonce_1_ok
  s_sleep 2
  buffer_load_dword v21, v20, s[32:35], 0 offen sc1
  s_waitcnt vmcnt(0)
  s_branch Lnonce_1
Lnonce_1_ok:
  s_cmp_eq_u32 s93, 0
  s_cbranch_scc1 Lnofl_1
  s_mov_b64 exec, 1
  buffer_store_dword v21, v20, s[28:31], s93 offen sc1
  s_mov_b64 exec, -1
Lnofl_1:
  s_waitcnt lgkmcnt(8)
  v_mfma_f32_16x16x32_bf16 v[48:51], v[92:95], v[176:179], v[48:51]
  ds_read_b64_tr_b16 v[68:69], v14 offset:16384
  ds_read_b64_tr_b16 v[70:71], v14 offset:16896
  v_mfma_f32_16x16x32_bf16 v[52:55], v[92:95], v[180:183], v[52:55]
  ds_read_b64_tr_b16 v[72:73], v15 offset:16384
  s_waitcnt lgkmcnt(9)
  v_mfma_f32_16x16x32_bf16 v[56:59], v[96:99], v[176:179], v[56:59]
  ds_read_b64_tr_b16 v[74:75], v15 offset:16896
  v_mfma_f32_16x16x32_bf16 v[60:63], v[96:99], v[180:183], v[60:63]
  ds_read_b64_tr_b16 v[76:77], v14 offset:20480
  s_waitcnt lgkmcnt(9)
  v_mfma_f32_16x16x32_bf16 v[48:51], v[100:103], v[184:187], v[48:51]
  ds_read_b64_tr_b16 v[78:79], v14 offset:20992
  v_mfma_f32_16x16x32_bf16 v[52:55], v[100:103], v[188:191], v[52:55]
  ds_read_b64_tr_b16 v[80:81], v15 offset:20480
  s_waitcnt lgkmcnt(8)
  v_mfma_f32_16x16x32_bf16 v[56:59], v[104:107], v[184:187], v[56:59]
  ds_read_b64_tr_b16 v[82:83], v15 offset:20992
  v_mfma_f32_16x16x32_bf16 v[60:63], v[104:107], v[188:191], v[60:63]
  s_waitcnt lgkmcnt(6)
  v_mfma_f32_16x16x32_bf16 v[48:51], v[68:71], v[192:195], v[48:51]
  ds_read_b64_tr_b16 v[92:93], v14 offset:24576
  ds_read_b64_tr_b16 v[94:95], v14 offset:25088
  v_mfma_f32_16x16x32_bf16 v[52:55], v[68:71], v[196:199], v[52:55]
  ds_read_b64_tr_b16 v[96:97], v15 offset:24576
  s_waitcnt lgkmcnt(7)
  v_mfma_f32_16x16x32_bf16 v[56:59], v[72:75], v[192:195], v[56:59]
  ds_read_b64_tr_b16 v[98:99], v15 offset:25088
  v_mfma_f32_16x16x32_bf16 v[60:63], v[72:75], v[196:199], v[60:63]
  ds_read_b64_tr_b16 v[100:101], v14 offset:28672
  s_waitcnt lgkmcnt(7)
  v_mfma_f32_16x16x32_bf16 v[48:51], v[76:79], v[200:203], v[48:51]
  ds_read_b64_tr_b16 v[102:103], v14 offset:29184
  v_mfma_f32_16x16x32_bf16 v[52:55], v[76:79], v[204:207], v[52:55]
  ds_read_b64_tr_b16 v[104:105], v15 offset:28672
  s_waitcnt lgkmcnt(7)
  v_mfma_f32_16x16x32_bf16 v[56:59], v[80:83], v[200:203], v[56:59]
  ds_read_b64_tr_b16 v[106:107], v15 offset:29184
  v_mfma_f32_16x16x32_bf16 v[60:63], v[80:83], v[204:207], v[60:63]
  s_barrier
  s_cmp_eq_u32 s95, 0
  s_cbranch_scc1 Lnohp_1
  buffer_load_dword v0, v20, s[28:31], s95 offen sc1
Lnohp_1:
  s_cmp_lg_u32 s40, 7
  s_cbranch_scc1 Lnp0
  buffer_load_dword v0, v9, s[28:31], s63 offen sc1
Lnp0:
  s_waitcnt lgkmcnt(6)
  v_mfma_f32_16x16x32_bf16 v[48:51], v[92:95], v[208:211], v[48:51]
  ds_read_b64_tr_b16 v[68:69], v12 offset:16384
  ds_read_b64_tr_b16 v[70:71], v12 offset:16896
  v_mfma_f32_16x16x32_bf16 v[52:55], v[92:95], v[212:215], v[52:55]
  ds_read_b64_tr_b16 v[72:73], v13 offset:16384
  s_waitcnt lgkmcnt(7)
  v_mfma_f32_16x16x32_bf16 v[56:59], v[96:99], v[208:211], v[56:59]
  ds_read_b64_tr_b16 v[74:75], v13 offset:16896
  v_mfma_f32_16x16x32_bf16 v[60:63], v[96:99], v[212:215], v[60:63]
  ds_read_b64_tr_b16 v[76:77], v12 offset:20480
  s_waitcnt lgkmcnt(7)
  v_mfma_f32_16x16x32_bf16 v[48:51], v[100:103], v[216:219], v[48:51]
  ds_read_b64_tr_b16 v[78:79], v12 offset:20992
  v_mfma_f32_16x16x32_bf16 v[52:55], v[100:103], v[220:223], v[52:55]
  ds_read_b64_tr_b16 v[80:81], v13 offset:20480
  s_waitcnt lgkmcnt(7)
  v_mfma_f32_16x16x32_bf16 v[56:59], v[104:107], v[216:219], v[56:59]
  ds_read_b64_tr_b16 v[82:83], v13 offset:20992
  v_mfma_f32_16x16x32_bf16 v[60:63], v[104:107], v[220:223], v[60:63]
  s_waitcnt lgkmcnt(6)
  v_mfma_f32_16x16x32_bf16 v[48:51], v[68:71], v[224:227], v[48:51]
  ds_read_b64_tr_b16 v[92:93], v12 offset:24576
  ds_read_b64_tr_b16 v[94:95], v12 offset:25088
  v_mfma_f32_16x16x32_bf16 v[52:55], v[68:71], v[228:231], v[52:55]
  ds_read_b64_tr_b16 v[96:97], v13 offset:24576
  s_waitcnt lgkmcnt(7)
  v_mfma_f32_16x16x32_bf16 v[56:59], v[72:75], v[224:227], v[56:59]
  ds_read_b64_tr_b16 v[98:99], v13 offset:25088
  v_mfma_f32_16x16x32_bf16 v[60:63], v[72:75], v[228:231], v[60:63]
  ds_read_b64_tr_b16 v[100:101], v12 offset:28672
  s_waitcnt lgkmcnt(7)
  v_mfma_f32_16x16x32_bf16 v[48:51], v[76:79], v[232:235], v[48:51]
  ds_read_b64_tr_b16 v[102:103], v12 offset:29184
  v_mfma_f32_16x16x32_bf16 v[52:55], v[76:79], v[236:239], v[52:55]
  ds_read_b64_tr_b16 v[104:105], v13 offset:28672
  s_waitcnt lgkmcnt(7)
  v_mfma_f32_16x16x32_bf16 v[56:59], v[80:83], v[232:235], v[56:59]
  ds_read_b64_tr_b16 v[106:107], v13 offset:29184
  v_mfma_f32_16x16x32_bf16 v[60:63], v[80:83], v[236:239], v[60:63]
  s_cmp_eq_u32 s42, 0
  s_cbranch_scc1 Lnomk_1
  ds_read_b128 v[128:131], v23 offset:0
  ds_read_b128 v[132:135], v23 offset:1024
  ds_read_b128 v[136:139], v23 offset:2048
  ds_read_b128 v[140:143], v23 offset:3072
  ds_read_b128 v[144:147], v23 offset:4096
  ds_read_b128 v[148:151], v23 offset:5120
Lnomk_1:
  s_waitcnt lgkmcnt(0)
  s_barrier
  s_cmp_eq_u32 s95, 0
  s_cbranch_scc1 Lnohq_1
  s_waitcnt vmcnt(0)
  v_readfirstlane_b32 s58, v0
  s_nop 0
  s_cmp_eq_u32 s58, s49
  s_cselect_b32 s95, 0, s95
  s_cbranch_scc1 Lnohq_1
  buffer_load_dword v0, v20, s[28:31], s95 offen sc1
Lnohq_1:
  s_cmp_lg_u32 s40, 7
  s_cbranch_scc1 Lnp7
  s_cmp_lg_u32 s53, 0
  s_cbranch_scc1 Lck0
  s_cmp_lg_u32 s40, 7
  s_cbranch_scc1 Lck0_l
  s_waitcnt vmcnt(0)
  v_cmp_ne_u32 vcc, s49, v0
  s_nop 1
  s_cbranch_vccz Lck0_y
  buffer_load_dword v0, v9, s[28:31], s63 offen sc1
  s_branch Lck0
Lck0_l:
  ds_read_b32 v6, v25
  s_waitcnt lgkmcnt(0)
  v_readfirstlane_b32 s58, v6
  s_nop 0
  s_cmp_eq_u32 s58, 0
  s_cbranch_scc1 Lck0
Lck0_y:
  ds_write_b32 v25, v21
  s_mov_b32 m0, s65
  s_nop 0
  buffer_load_dwordx4 v2, s[28:31], s62 offen sc1 lds
  buffer_load_dwordx4 v2, s[28:31], s62 offen offset:1024 sc1 lds
  s_add_u32 m0, s65, 16640
  s_add_u32 s60, s62, 16384
  buffer_load_dwordx4 v2, s[28:31], s60 offen sc1 lds
  buffer_load_dwordx4 v2, s[28:31], s60 offen offset:1024 sc1 lds
  s_mov_b32 s53, 1
Lck0:
Lnp7:
  v_mfma_f32_16x16x32_bf16 v[48:51], v[92:95], v[240:243], v[48:51]
  v_mfma_f32_16x16x32_bf16 v[52:55], v[92:95], v[244:247], v[52:55]
  v_mfma_f32_16x16x32_bf16 v[56:59], v[96:99], v[240:243], v[56:59]
  v_mfma_f32_16x16x32_bf16 v[60:63], v[96:99], v[244:247], v[60:63]
  v_mfma_f32_16x16x32_bf16 v[48:51], v[100:103], v[248:251], v[48:51]
  v_mfma_f32_16x16x32_bf16 v[52:55], v[100:103], v[252:255], v[52:55]
  v_mfma_f32_16x16x32_bf16 v[56:59], v[104:107], v[248:251], v[56:59]
  v_mfma_f32_16x16x32_bf16 v[60:63], v[104:107], v[252:255], v[60:63]
  s_setprio 0
LPdone:
  s_mov_b64 exec, 0xffff
  ds_write_b128 v4, v[64:67] offset:2048
  s_mov_b64 exec, -1
  v_mov_b32 v13, 0xdddddddd
  s_cmp_lg_u32 s42, 0
  s_cbranch_scc1 LBdone
  s_nop 2
  v_pk_mul_f32 v[48:49], v[48:49], s[100:101] op_sel_hi:[1,0]
  v_pk_mul_f32 v[50:51], v[50:51], s[100:101] op_sel_hi:[1,0]
  v_pk_mul_f32 v[52:53], v[52:53], s[100:101] op_sel_hi:[1,0]
  v_pk_mul_f32 v[54:55], v[54:55], s[100:101] op_sel_hi:[1,0]
  v_pk_mul_f32 v[56:57], v[56:57], s[100:101] op_sel_hi:[1,0]
  v_pk_mul_f32 v[58:59], v[58:59], s[100:101] op_sel_hi:[1,0]
  v_pk_mul_f32 v[60:61], v[60:61], s[100:101] op_sel_hi:[1,0]
  v_pk_mul_f32 v[62:63], v[62:63], s[100:101] op_sel_hi:[1,0]
  v_cvt_pk_bf16_f32 v116, v48, v49
  v_cvt_pk_bf16_f32 v117, v50, v51
  v_cvt_pk_bf16_f32 v118, v52, v53
  v_cvt_pk_bf16_f32 v119, v54, v55
  v_cvt_pk_bf16_f32 v120, v56, v57
  v_cvt_pk_bf16_f32 v121, v58, v59
  v_cvt_pk_bf16_f32 v122, v60, v61
  v_cvt_pk_bf16_f32 v123, v62, v63
  v_min_u32 v116, -2, v116
  v_min_u32 v117, -2, v117
  v_min_u32 v118, -2, v118
  v_min_u32 v119, -2, v119
  v_min_u32 v120, -2, v120
  v_min_u32 v121, -2, v121
  v_min_u32 v122, -2, v122
  v_min_u32 v123, -2, v123
  v_permlane16_swap_b32 v116, v118
  v_permlane16_swap_b32 v117, v119
  s_add_u32 s56, s7, 65536
  s_cmp_lg_u32 s53, 0
  s_cbranch_scc1 Lck1
  s_cmp_lg_u32 s40, 7
  s_cbranch_scc1 Lck1_l
  s_waitcnt vmcnt(0)
  v_cmp_ne_u32 vcc, s49, v0
  s_nop 1
  s_cbranch_vccz Lck1_y
  buffer_load_dword v0, v9, s[28:31], s63 offen sc1
  s_branch Lck1
Lck1_l:
  ds_read_b32 v6, v25
  s_waitcnt lgkmcnt(0)
  v_readfirstlane_b32 s58, v6
  s_nop 0
  s_cmp_eq_u32 s58, 0
  s_cbranch_scc1 Lck1
Lck1_y:
  ds_write_b32 v25, v21
  s_mov_b32 m0, s65
  s_nop 0
  buffer_load_dwordx4 v2, s[28:31], s62 offen sc1 lds
  buffer_load_dwordx4 v2, s[28:31], s62 offen offset:1024 sc1 lds
  s_add_u32 m0, s65, 16640
  s_add_u32 s60, s62, 16384
  buffer_load_dwordx4 v2, s[28:31], s60 offen sc1 lds
  buffer_load_dwordx4 v2, s[28:31], s60 offen offset:1024 sc1 lds
  s_mov_b32 s53, 1
Lck1:
  buffer_store_dwordx4 v[116:119], v2, s[28:31], s7 offen sc1
  v_permlane16_swap_b32 v120, v122
  v_permlane16_swap_b32 v121, v123
  buffer_store_dwordx4 v[120:123], v2, s[28:31], s56 offen sc1
  s_cmp_lg_u32 s53, 0
  s_cbranch_scc1 Lck2
  s_cmp_lg_u32 s40, 7
  s_cbranch_scc1 Lck2_l
  s_waitcnt vmcnt(0)
  v_cmp_ne_u32 vcc, s49, v0
  s_nop 1
  s_cbranch_vccz Lck2_y
  buffer_load_dword v0, v9, s[28:31], s63 offen sc1
  s_branch Lck2
Lck2_l:
  ds_read_b32 v6, v25
  s_waitcnt lgkmcnt(0)
  v_readfirstlane_b32 s58, v6
  s_nop 0
  s_cmp_eq_u32 s58, 0
  s_cbranch_scc1 Lck2
Lck2_y:
  ds_write_b32 v25, v21
  s_mov_b32 m0, s65
  s_nop 0
  buffer_load_dwordx4 v2, s[28:31], s62 offen sc1 lds
  buffer_load_dwordx4 v2, s[28:31], s62 offen offset:1024 sc1 lds
  s_add_u32 m0, s65, 16640
  s_add_u32 s60, s62, 16384
  buffer_load_dwordx4 v2, s[28:31], s60 offen sc1 lds
  buffer_load_dwordx4 v2, s[28:31], s60 offen offset:1024 sc1 lds
  s_mov_b32 s53, 1
Lck2:
  s_cmp_lg_u32 s5, 0
  s_cbranch_scc1 Lnog1
  ds_read_b128 v[84:87], v11 offset:0
  ds_read_b128 v[88:91], v11 offset:64
  ds_read_b128 v[92:95], v11 offset:128
  ds_read_b128 v[96:99], v11 offset:192
  ds_read_b128 v[100:103], v11 offset:256
  ds_read_b128 v[104:107], v11 offset:320
  ds_read_b128 v[108:111], v11 offset:384
  ds_read_b128 v[112:115], v11 offset:448
  s_cmp_lg_u32 s47, 0
  s_cbranch_scc1 Lgm1
  s_waitcnt lgkmcnt(7)
  v_mfma_f32_16x16x32_bf16 v[40:43], v[84:87], v[128:131], 0
  v_mfma_f32_16x16x32_bf16 v[44:47], v[84:87], v[132:135], 0
  s_waitcnt lgkmcnt(6)
  v_mfma_f32_16x16x32_bf16 v[40:43], v[88:91], v[136:139], v[40:43]
  v_mfma_f32_16x16x32_bf16 v[44:47], v[88:91], v[140:143], v[44:47]
  s_waitcnt lgkmcnt(5)
  v_mfma_f32_16x16x32_bf16 v[40:43], v[92:95], v[144:147], v[40:43]
  v_mfma_f32_16x16x32_bf16 v[44:47], v[92:95], v[148:151], v[44:47]
  s_waitcnt lgkmcnt(4)
  v_mfma_f32_16x16x32_bf16 v[40:43], v[96:99], v[152:155], v[40:43]
  v_mfma_f32_16x16x32_bf16 v[44:47], v[96:99], v[156:159], v[44:47]
  s_waitcnt lgkmcnt(3)
  v_mfma_f32_16x16x32_bf16 v[40:43], v[100:103], v[160:163], v[40:43]
  v_mfma_f32_16x16x32_bf16 v[44:47], v[100:103], v[164:167], v[44:47]
  s_waitcnt lgkmcnt(2)
  v_mfma_f32_16x16x32_bf16 v[40:43], v[104:107], v[168:171], v[40:43]
  v_mfma_f32_16x16x32_bf16 v[44:47], v[104:107], v[172:175], v[44:47]
  s_waitcnt lgkmcnt(1)
  v_mfma_f32_16x16x32_bf16 v[40:43], v[108:111], v[176:179], v[40:43]
  v_mfma_f32_16x16x32_bf16 v[44:47], v[108:111], v[180:183], v[44:47]
  s_waitcnt lgkmcnt(0)
  v_mfma_f32_16x16x32_bf16 v[40:43], v[112:115], v[184:187], v[40:43]
  v_mfma_f32_16x16x32_bf16 v[44:47], v[112:115], v[188:191], v[44:47]
  s_branch Lgm2
Lgm1:
  s_waitcnt lgkmcnt(7)
  v_mfma_f32_16x16x32_bf16 v[40:43], v[84:87], v[192:195], 0
  v_mfma_f32_16x16x32_bf16 v[44:47], v[84:87], v[196:199], 0
  s_waitcnt lgkmcnt(6)
  v_mfma_f32_16x16x32_bf16 v[40:43], v[88:91], v[200:203], v[40:43]
  v_mfma_f32_16x16x32_bf16 v[44:47], v[88:91], v[204:207], v[44:47]
  s_waitcnt lgkmcnt(5)
  v_mfma_f32_16x16x32_bf16 v[40:43], v[92:95], v[208:211], v[40:43]
  v_mfma_f32_16x16x32_bf16 v[44:47], v[92:95], v[212:215], v[44:47]
  s_waitcnt lgkmcnt(4)
  v_mfma_f32_16x16x32_bf16 v[40:43], v[96:99], v[216:219], v[40:43]
  v_mfma_f32_16x16x32_bf16 v[44:47], v[96:99], v[220:223], v[44:47]
  s_waitcnt lgkmcnt(3)
  v_mfma_f32_16x16x32_bf16 v[40:43], v[100:103], v[224:227], v[40:43]
  v_mfma_f32_16x16x32_bf16 v[44:47], v[100:103], v[228:231], v[44:47]
  s_waitcnt lgkmcnt(2)
  v_mfma_f32_16x16x32_bf16 v[40:43], v[104:107], v[232:235], v[40:43]
  v_mfma_f32_16x16x32_bf16 v[44:47], v[104:107], v[236:239], v[44:47]
  s_waitcnt lgkmcnt(1)
  v_mfma_f32_16x16x32_bf16 v[40:43], v[108:111], v[240:243], v[40:43]
  v_mfma_f32_16x16x32_bf16 v[44:47], v[108:111], v[244:247], v[44:47]
  s_waitcnt lgkmcnt(0)
  v_mfma_f32_16x16x32_bf16 v[40:43], v[112:115], v[248:251], v[40:43]
  v_mfma_f32_16x16x32_bf16 v[44:47], v[112:115], v[252:255], v[44:47]
Lgm2:
  s_nop 5
  s_mov_b32 vcc_lo, 0x0000ffff
  s_mov_b32 vcc_hi, 0x0000ffff
  v_cndmask_b32 v18, v44, v40, vcc
  ds_write_b32 v27, v18
  s_waitcnt lgkmcnt(0)
  s_barrier
  s_cmp_lg_u32 s47, 0
  s_cbranch_scc1 Lnog1
  ds_read_b64 v[40:41], v27
  s_lshl_b32 s56, s41, 2
  s_add_u32 s56, s56, s48
  s_lshl_b32 s56, s56, 7
  s_add_u32 s56, s56, 13631488
  s_waitcnt lgkmcnt(0)
  v_add_f32 v18, v40, v41
  v_cvt_pk_bf16_f32 v18, v18, v18
  v_lshlrev_b32 v18, 16, v18
  v_mul_f32 v18, 0xbfb8aa3b, v18
  v_exp_f32 v18, v18
  s_nop 0
  v_add_f32 v18, 1.0, v18
  v_rcp_f32 v18, v18
  s_nop 0
  v_cvt_pk_bf16_f32 v18, v18, v18
  v_lshlrev_b32 v22, 16, v18
  s_mov_b64 exec, 0xffffffff
  buffer_store_dword v22, v24, s[28:31], s56 offen sc1
  s_mov_b64 exec, -1
Lnog1:
  s_branch Lwait
LBdone:
  s_cmp_lg_u32 s48, 0
  s_cbranch_scc1 Lnoh
  s_mov_b32 s61, 0
  s_cmp_eq_u32 s95, 0
  s_cbranch_scc1 Lhok
Lhp:
  s_waitcnt vmcnt(0)
  v_readfirstlane_b32 s58, v0
  s_add_u32 s61, s61, 1
  s_cmp_eq_u32 s58, s49
  s_cbranch_scc1 Lhok
  s_cmp_gt_u32 s61, 262144
  s_cbranch_scc1 Lhok
  buffer_load_dword v0, v20, s[28:31], s95 offen sc1
  s_branch Lhp
Lhok:
  buffer_load_dwordx4 v[84:87], v2, s[28:31], s94 offen sc1
  buffer_load_dwordx4 v[88:91], v2, s[28:31], s94 offen offset:1024 sc1
  s_cmp_lg_u32 s41, 0
  s_cbranch_scc1 Lnoh
  v_mov_b32 v144, 0xf149f2ca
  v_mov_b32 v145, 0xf149f2ca
  v_mov_b32 v146, 0xf149f2ca
  v_mov_b32 v147, 0xf149f2ca
  v_mov_b32 v148, 0xf149f2ca
  v_mov_b32 v149, 0xf149f2ca
  v_mov_b32 v150, 0xf149f2ca
  v_mov_b32 v151, 0xf149f2ca
Lnoh:
  v_cvt_pk_bf16_f32 v68, v48, v49
  v_cvt_pk_bf16_f32 v69, v50, v51
  v_cvt_pk_bf16_f32 v70, v52, v53
  v_cvt_pk_bf16_f32 v71, v54, v55
  v_cvt_pk_bf16_f32 v72, v56, v57
  v_cvt_pk_bf16_f32 v73, v58, v59
  v_cvt_pk_bf16_f32 v74, v60, v61
  v_cvt_pk_bf16_f32 v75, v62, v63
  v_permlane16_swap_b32 v68, v70
  v_permlane16_swap_b32 v69, v71
  v_mov_b64 v[224:225], 0
  v_mov_b64 v[226:227], 0
  v_permlane16_swap_b32 v72, v74
  v_permlane16_swap_b32 v73, v75
  v_mfma_f32_32x32x16_bf16 v[160:175], v[116:119], v[68:71], v[128:143]
  v_mov_b64 v[228:229], 0
  v_mov_b64 v[230:231], 0
  v_mov_b64 v[232:233], 0
  v_mov_b64 v[234:235], 0
  v_mov_b64 v[236:237], 0
  v_mov_b64 v[238:239], 0
  v_mfma_f32_32x32x16_bf16 v[192:207], v[120:123], v[72:75], v[128:143]
  v_mov_b64 v[240:241], 0
  v_mov_b64 v[242:243], 0
  v_mov_b64 v[244:245], 0
  v_mov_b64 v[246:247], 0
  v_mov_b64 v[248:249], 0
  v_mov_b64 v[250:251], 0
  v_mov_b64 v[252:253], 0
  v_mov_b64 v[254:255], 0
  s_cmp_eq_u32 s48, 0
  s_cbranch_scc1 Lq2
  s_cmp_lg_u32 s53, 0
  s_cbranch_scc1 Lck3
  s_cmp_lg_u32 s40, 7
  s_cbranch_scc1 Lck3_l
  s_waitcnt vmcnt(0)
  v_cmp_ne_u32 vcc, s49, v0
  s_nop 1
  s_cbranch_vccz Lck3_y
  buffer_load_dword v0, v9, s[28:31], s63 offen sc1
  s_branch Lck3
Lck3_l:
  ds_read_b32 v6, v25
  s_waitcnt lgkmcnt(0)
  v_readfirstlane_b32 s58, v6
  s_nop 0
  s_cmp_eq_u32 s58, 0
  s_cbranch_scc1 Lck3
Lck3_y:
  ds_write_b32 v25, v21
  s_mov_b32 m0, s65
  s_nop 0
  buffer_load_dwordx4 v2, s[28:31], s62 offen sc1 lds
  buffer_load_dwordx4 v2, s[28:31], s62 offen offset:1024 sc1 lds
  s_add_u32 m0, s65, 16640
  s_add_u32 s60, s62, 16384
  buffer_load_dwordx4 v2, s[28:31], s60 offen sc1 lds
  buffer_load_dwordx4 v2, s[28:31], s60 offen offset:1024 sc1 lds
  s_mov_b32 s53, 1
Lck3:
Lq2:
  v_max3_f32 v76, v160, v161, v162
  v_max3_f32 v76, v76, v163, v164
  v_max3_f32 v76, v76, v165, v166
  v_max3_f32 v76, v76, v167, v168
  v_max3_f32 v76, v76, v169, v170
  v_max3_f32 v76, v76, v171, v172
  v_max3_f32 v76, v76, v173, v174
  v_max3_f32 v78, v192, v193, v194
  v_max3_f32 v78, v78, v195, v196
  v_max3_f32 v78, v78, v197, v198
  v_max3_f32 v78, v78, v199, v200
  v_max3_f32 v78, v78, v201, v202
  v_max3_f32 v78, v78, v203, v204
  v_max3_f32 v78, v78, v205, v206
  s_cmp_lg_u32 s48, 0
  s_cbranch_scc1 Lnoh2
  s_waitcnt vmcnt(0)
Lnoh2:
  v_mfma_f32_32x32x16_bf16 v[176:191], v[84:87], v[68:71], v[136:151]
  v_mfma_f32_32x32x16_bf16 v[208:223], v[88:91], v[72:75], v[136:151]
  s_mov_b32 vcc_lo, 0xffff0000
  s_mov_b32 vcc_hi, 0xffff0000
  v_cndmask_b32 v108, v84, v44, vcc
  v_cndmask_b32 v109, v85, v44, vcc
  v_cndmask_b32 v110, v86, v44, vcc
  v_cndmask_b32 v111, v87, v44, vcc
  v_cndmask_b32 v112, v88, v44, vcc
  v_cndmask_b32 v113, v89, v44, vcc
  v_cndmask_b32 v114, v90, v44, vcc
  v_cndmask_b32 v115, v91, v44, vcc
  s_cmp_lg_u32 s53, 0
  s_cbranch_scc1 Lck4
  s_cmp_lg_u32 s40, 7
  s_cbranch_scc1 Lck4_l
  s_waitcnt vmcnt(0)
  v_cmp_ne_u32 vcc, s49, v0
  s_nop 1
  s_cbranch_vccz Lck4_y
  buffer_load_dword v0, v9, s[28:31], s63 offen sc1
  s_branch Lck4
Lck4_l:
  ds_read_b32 v6, v25
  s_waitcnt lgkmcnt(0)
  v_readfirstlane_b32 s58, v6
  s_nop 0
  s_cmp_eq_u32 s58, 0
  s_cbranch_scc1 Lck4
Lck4_y:
  ds_write_b32 v25, v21
  s_mov_b32 m0, s65
  s_nop 0
  buffer_load_dwordx4 v2, s[28:31], s62 offen sc1 lds
  buffer_load_dwordx4 v2, s[28:31], s62 offen offset:1024 sc1 lds
  s_add_u32 m0, s65, 16640
  s_add_u32 s60, s62, 16384
  buffer_load_dwordx4 v2, s[28:31], s60 offen sc1 lds
  buffer_load_dwordx4 v2, s[28:31], s60 offen offset:1024 sc1 lds
  s_mov_b32 s53, 1
Lck4:
  s_nop 1
  v_max3_f32 v76, v76, v175, v184
  v_max3_f32 v76, v76, v185, v186
  v_max3_f32 v76, v76, v187, v188
  v_max3_f32 v76, v76, v189, v190
  v_max_f32 v76, v76, v191
  v_mov_b32 v77, v76
  v_max3_f32 v78, v78, v207, v216
  v_max3_f32 v78, v78, v217, v218
  v_max3_f32 v78, v78, v219, v220
  v_max3_f32 v78, v78, v221, v222
  v_max_f32 v78, v78, v223
  v_mov_b32 v79, v78
  s_nop 0
  v_permlane32_swap_b32 v76, v77
  v_permlane32_swap_b32 v78, v79
  v_max_f32 v76, v76, v77
  v_max_f32 v78, v78, v79
  v_mul_f32 v76, 0xbeb8aa3b, v76
  v_mul_f32 v78, 0xbeb8aa3b, v78
  v_pk_fma_f32 v[160:161], v[160:161], s[100:101], v[76:77] op_sel_hi:[1,0,0]
  v_pk_fma_f32 v[162:163], v[162:163], s[100:101], v[76:77] op_sel_hi:[1,0,0]
  v_pk_fma_f32 v[164:165], v[164:165], s[100:101], v[76:77] op_sel_hi:[1,0,0]
  v_pk_fma_f32 v[166:167], v[166:167], s[100:101], v[76:77] op_sel_hi:[1,0,0]
  v_pk_fma_f32 v[168:169], v[168:169], s[100:101], v[76:77] op_sel_hi:[1,0,0]
  v_pk_fma_f32 v[170:171], v[170:171], s[100:101], v[76:77] op_sel_hi:[1,0,0]
  v_pk_fma_f32 v[172:173], v[172:173], s[100:101], v[76:77] op_sel_hi:[1,0,0]
  v_pk_fma_f32 v[174:175], v[174:175], s[100:101], v[76:77] op_sel_hi:[1,0,0]
  v_pk_fma_f32 v[184:185], v[184:185], s[100:101], v[76:77] op_sel_hi:[1,0,0]
  v_pk_fma_f32 v[186:187], v[186:187], s[100:101], v[76:77] op_sel_hi:[1,0,0]
  v_pk_fma_f32 v[188:189], v[188:189], s[100:101], v[76:77] op_sel_hi:[1,0,0]
  v_pk_fma_f32 v[190:191], v[190:191], s[100:101], v[76:77] op_sel_hi:[1,0,0]
  v_exp_f32 v160, v160
  v_exp_f32 v161, v161
  v_exp_f32 v162, v162
  v_exp_f32 v163, v163
  v_exp_f32 v164, v164
  v_exp_f32 v165, v165
  v_exp_f32 v166, v166
  v_exp_f32 v167, v167
  v_exp_f32 v168, v168
  v_exp_f32 v169, v169
  v_exp_f32 v170, v170
  v_exp_f32 v171, v171
  v_exp_f32 v172, v172
  v_exp_f32 v173, v173
  v_exp_f32 v174, v174
  v_exp_f32 v175, v175
  v_smfmac_f32_32x32x32_bf16 v[224:239], v[124:127], v[160:167], v13
  v_exp_f32 v184, v184
  v_exp_f32 v185, v185
  v_exp_f32 v186, v186
  v_exp_f32 v187, v187
  v_exp_f32 v188, v188
  v_exp_f32 v189, v189
  v_exp_f32 v190, v190
  v_exp_f32 v191, v191
  v_smfmac_f32_32x32x32_bf16 v[224:239], v[36:39], v[168:175], v13
  s_cmp_lg_u32 s53, 0
  s_cbranch_scc1 Lck5
  s_cmp_lg_u32 s40, 7
  s_cbranch_scc1 Lck5_l
  s_waitcnt vmcnt(0)
  v_cmp_ne_u32 vcc, s49, v0
  s_nop 1
  s_cbranch_vccz Lck5_y
  buffer_load_dword v0, v9, s[28:31], s63 offen sc1
  s_branch Lck5
Lck5_l:
  ds_read_b32 v6, v25
  s_waitcnt lgkmcnt(0)
  v_readfirstlane_b32 s58, v6
  s_nop 0
  s_cmp_eq_u32 s58, 0
  s_cbranch_scc1 Lck5
Lck5_y:
  ds_write_b32 v25, v21
  s_mov_b32 m0, s65
  s_nop 0
  buffer_load_dwordx4 v2, s[28:31], s62 offen sc1 lds
  buffer_load_dwordx4 v2, s[28:31], s62 offen offset:1024 sc1 lds
  s_add_u32 m0, s65, 16640
  s_add_u32 s60, s62, 16384
  buffer_load_dwordx4 v2, s[28:31], s60 offen sc1 lds
  buffer_load_dwordx4 v2, s[28:31], s60 offen offset:1024 sc1 lds
  s_mov_b32 s53, 1
Lck5:
  s_cmp_lg_u32 s53, 1
  s_cbranch_scc1 Lnq
  buffer_load_dwordx4 v[28:31], v2, s[28:31], s15 offen sc1
  s_mov_b32 s53, 2
Lnq:
  v_pk_fma_f32 v[192:193], v[192:193], s[100:101], v[78:79] op_sel_hi:[1,0,0]
  v_pk_fma_f32 v[194:195], v[194:195], s[100:101], v[78:79] op_sel_hi:[1,0,0]
  v_pk_fma_f32 v[196:197], v[196:197], s[100:101], v[78:79] op_sel_hi:[1,0,0]
  v_pk_fma_f32 v[198:199], v[198:199], s[100:101], v[78:79] op_sel_hi:[1,0,0]
  v_pk_fma_f32 v[200:201], v[200:201], s[100:101], v[78:79] op_sel_hi:[1,0,0]
  v_pk_fma_f32 v[202:203], v[202:203], s[100:101], v[78:79] op_sel_hi:[1,0,0]
  v_pk_fma_f32 v[204:205], v[204:205], s[100:101], v[78:79] op_sel_hi:[1,0,0]
  v_pk_fma_f32 v[206:207], v[206:207], s[100:101], v[78:79] op_sel_hi:[1,0,0]
  v_pk_fma_f32 v[216:217], v[216:217], s[100:101], v[78:79] op_sel_hi:[1,0,0]
  v_pk_fma_f32 v[218:219], v[218:219], s[100:101], v[78:79] op_sel_hi:[1,0,0]
  v_pk_fma_f32 v[220:221], v[220:221], s[100:101], v[78:79] op_sel_hi:[1,0,0]
  v_pk_fma_f32 v[222:223], v[222:223], s[100:101], v[78:79] op_sel_hi:[1,0,0]
  v_smfmac_f32_32x32x32_bf16 v[224:239], v[108:111], v[184:191], v13
  v_exp_f32 v192, v192
  v_exp_f32 v193, v193
  v_exp_f32 v194, v194
  v_exp_f32 v195, v195
  v_exp_f32 v196, v196
  v_exp_f32 v197, v197
  v_exp_f32 v198, v198
  v_exp_f32 v199, v199
  v_exp_f32 v200, v200
  v_exp_f32 v201, v201
  v_exp_f32 v202, v202
  v_exp_f32 v203, v203
  v_exp_f32 v204, v204
  v_exp_f32 v205, v205
  v_exp_f32 v206, v206
  v_exp_f32 v207, v207
  v_smfmac_f32_32x32x32_bf16 v[240:255], v[32:35], v[192:199], v13
  v_exp_f32 v216, v216
  v_exp_f32 v217, v217
  v_exp_f32 v218, v218
  v_exp_f32 v219, v219
  v_exp_f32 v220, v220
  v_exp_f32 v221, v221
  v_exp_f32 v222, v222
  v_exp_f32 v223, v223
  v_smfmac_f32_32x32x32_bf16 v[240:255], v[40:43], v[200:207], v13
  v_rcp_f32 v76, v232
  s_nop 0
  v_smfmac_f32_32x32x32_bf16 v[240:255], v[112:115], v[216:223], v13
  v_pk_mul_f32 v[224:225], v[224:225], v[76:77] op_sel_hi:[1,0]
  v_pk_mul_f32 v[226:227], v[226:227], v[76:77] op_sel_hi:[1,0]
  v_pk_mul_f32 v[228:229], v[228:229], v[76:77] op_sel_hi:[1,0]
  v_pk_mul_f32 v[230:231], v[230:231], v[76:77] op_sel_hi:[1,0]
  v_cvt_pk_bf16_f32 v136, v224, v225
  v_cvt_pk_bf16_f32 v137, v226, v227
  v_cvt_pk_bf16_f32 v138, v228, v229
  v_cvt_pk_bf16_f32 v139, v230, v231
  s_nop 3
  v_rcp_f32 v76, v248
  s_nop 0
  v_pk_mul_f32 v[240:241], v[240:241], v[76:77] op_sel_hi:[1,0]
  v_pk_mul_f32 v[242:243], v[242:243], v[76:77] op_sel_hi:[1,0]
  v_pk_mul_f32 v[244:245], v[244:245], v[76:77] op_sel_hi:[1,0]
  v_pk_mul_f32 v[246:247], v[246:247], v[76:77] op_sel_hi:[1,0]
  v_cvt_pk_bf16_f32 v140, v240, v241
  v_cvt_pk_bf16_f32 v141, v242, v243
  v_cvt_pk_bf16_f32 v142, v244, v245
  v_cvt_pk_bf16_f32 v143, v246, v247
Lwait:
  v_mov_b64 v[128:129], -1
  v_mov_b64 v[130:131], -1
  s_mov_b32 s36, s66
  s_mov_b32 s37, s67
  s_mov_b32 s38, 2097152
  s_mov_b32 s39, 0x20000
  s_lshl_b32 s56, s44, 2
  s_add_u32 s56, s56, s48
  s_lshl_b32 s56, s56, 16
  s_lshl_b32 s57, s47, 14
  s_add_u32 s58, s56, s57
  s_add_u32 s51, s58, 11534336
  s_lshl_b32 s56, s41, 2
  s_add_u32 s56, s56, s43
  s_lshl_b32 s56, s56, 16
  s_add_u32 s56, s56, s57
  s_add_u32 s50, s56, 6324224
  s_cmp_eq_u32 s42, 0
  s_cselect_b32 s0, 0x7ff00000, s64
  s_cselect_b32 s64, s64, 0x7ff00000
  v_mov_b64 v[48:49], 0
  v_mov_b64 v[50:51], 0
  v_mov_b64 v[52:53], 0
  v_mov_b64 v[54:55], 0
  v_mov_b64 v[56:57], 0
  v_mov_b64 v[58:59], 0
  v_mov_b64 v[60:61], 0
  v_mov_b64 v[62:63], 0
  v_mov_b64 v[120:121], 0
  v_mov_b64 v[122:123], 0
  v_mov_b64 v[124:125], 0
  v_mov_b64 v[126:127], 0
  v_mov_b32 v14, v2
  v_mov_b32 v15, v16
  v_mov_b32 v16, v17
  s_mov_b32 s61, 0
Lspin:
  s_cmp_lg_u32 s53, 0
  s_cbranch_scc1 Lck6
  s_cmp_lg_u32 s40, 7
  s_cbranch_scc1 Lck6_l
  s_waitcnt vmcnt(0)
  v_cmp_ne_u32 vcc, s49, v0
  s_nop 1
  s_cbranch_vccz Lck6_y
  buffer_load_dword v0, v9, s[28:31], s63 offen sc1
  s_branch Lck6
Lck6_l:
  ds_read_b32 v6, v25
  s_waitcnt lgkmcnt(0)
  v_readfirstlane_b32 s58, v6
  s_nop 0
  s_cmp_eq_u32 s58, 0
  s_cbranch_scc1 Lck6
Lck6_y:
  ds_write_b32 v25, v21
  s_mov_b32 m0, s65
  s_nop 0
  buffer_load_dwordx4 v2, s[28:31], s62 offen sc1 lds
  buffer_load_dwordx4 v2, s[28:31], s62 offen offset:1024 sc1 lds
  s_add_u32 m0, s65, 16640
  s_add_u32 s60, s62, 16384
  buffer_load_dwordx4 v2, s[28:31], s60 offen sc1 lds
  buffer_load_dwordx4 v2, s[28:31], s60 offen offset:1024 sc1 lds
  s_mov_b32 s53, 1
Lck6:
  s_cmp_lg_u32 s53, 0
  s_cbranch_scc1 Lrdy
  s_add_u32 s61, s61, 1
  s_sleep 1
  s_cmp_lt_u32 s61, 262144
  s_cbranch_scc1 Lspin
Lrdy:
  s_cmp_eq_u32 s53, 2
  s_cbranch_scc1 Lnq2
  buffer_load_dwordx4 v[28:31], v2, s[28:31], s15 offen sc1
Lnq2:
  s_waitcnt vmcnt(1)
  s_waitcnt lgkmcnt(0)
  s_barrier
  ds_read_b128 v[96:99], v2
  ds_read_b128 v[104:107], v8
  ds_read_b128 v[100:103], v7
  s_mov_b32 s61, 0
Lqp:
  s_waitcnt vmcnt(0)
  v_max3_u32 v9, v28, v29, v30
  v_max_u32 v9, v9, v31
  v_cmp_eq_u32 vcc, -1, v9
  s_add_u32 s61, s61, 1
  s_cmp_gt_u32 s61, 262144
  s_cbranch_vccz Lqok
  s_cbranch_scc1 Lqok
  s_sleep 4
  buffer_load_dwordx4 v[28:31], v2, s[28:31], s15 offen sc1
  s_branch Lqp
Lqok:
  s_mov_b32 s54, 0
  s_mov_b32 s63, 10485760
  s_waitcnt lgkmcnt(2)
  v_mfma_f32_32x32x16_bf16 v[64:79], v[96:99], v[28:31], 0
  s_nop 1
  s_nop 9
  v_max3_f32 v9, v64, v65, v66
  v_max3_f32 v9, v9, v67, v68
  v_max3_f32 v9, v9, v69, v70
  v_max3_f32 v9, v9, v71, v72
  v_max3_f32 v9, v9, v73, v74
  v_max3_f32 v9, v9, v75, v76
  v_max3_f32 v9, v9, v77, v78
  v_max_f32 v9, v9, v79
  v_mov_b32 v10, v9
  s_nop 1
  v_permlane32_swap_b32 v9, v10
  v_max_f32 v9, v9, v10
  ds_read_b128 v[96:99], v2 offset:2080
  v_sub_f32 v32, 0, v9
  v_sub_f32 v33, 0, v9
  v_mov_b64 v[34:35], v[32:33]
  v_mov_b64 v[36:37], v[32:33]
  v_mov_b64 v[38:39], v[32:33]
  v_mov_b64 v[40:41], v[32:33]
  v_mov_b64 v[42:43], v[32:33]
  v_mov_b64 v[44:45], v[32:33]
  v_mov_b64 v[46:47], v[32:33]
  v_pk_add_f32 v[64:65], v[64:65], v[32:33]
  v_pk_add_f32 v[66:67], v[66:67], v[32:33]
  v_pk_add_f32 v[68:69], v[68:69], v[32:33]
  v_pk_add_f32 v[70:71], v[70:71], v[32:33]
  v_pk_add_f32 v[72:73], v[72:73], v[32:33]
  v_pk_add_f32 v[74:75], v[74:75], v[32:33]
  v_pk_add_f32 v[76:77], v[76:77], v[32:33]
  v_pk_add_f32 v[78:79], v[78:79], v[32:33]
  s_waitcnt lgkmcnt(0)
  s_setprio 3
  v_mfma_f32_32x32x16_bf16 v[80:95], v[96:99], v[28:31], v[32:47]
  ds_read_b128 v[96:99], v14 offset:4160
  v_exp_f32 v64, v64
  v_exp_f32 v65, v65
  v_exp_f32 v66, v66
  v_exp_f32 v67, v67
  v_exp_f32 v68, v68
  v_smfmac_f32_32x32x32_bf16 v[48:63], v[104:107], v[120:127], v13
  ds_read_b128 v[104:107], v16 offset:0
  s_add_u32 m0, s65, 33280
  s_add_u32 s60, s62, 32768
  buffer_load_dwordx4 v2, s[28:31], s60 offen sc1 lds
  buffer_load_dwordx4 v2, s[28:31], s60 offen offset:1024 sc1 lds
  v_exp_f32 v69, v69
  v_exp_f32 v70, v70
  v_exp_f32 v71, v71
  v_exp_f32 v72, v72
  v_exp_f32 v73, v73
  v_exp_f32 v74, v74
  v_smfmac_f32_32x32x32_bf16 v[48:63], v[100:103], v[64:71], v13
  ds_read_b128 v[100:103], v15 offset:2080
  v_exp_f32 v75, v75
  v_exp_f32 v76, v76
  v_exp_f32 v77, v77
  v_exp_f32 v78, v78
  v_exp_f32 v79, v79
  s_waitcnt lgkmcnt(1)
  v_mfma_f32_32x32x16_bf16 v[112:127], v[96:99], v[28:31], v[32:47]
  ds_read_b128 v[96:99], v14 offset:6240
  v_exp_f32 v80, v80
  v_exp_f32 v81, v81
  v_exp_f32 v82, v82
  v_exp_f32 v83, v83
  v_exp_f32 v84, v84
  v_smfmac_f32_32x32x32_bf16 v[48:63], v[104:107], v[72:79], v13
  ds_read_b128 v[104:107], v16 offset:2080
  s_add_u32 m0, s65, 49920
  s_add_u32 s60, s62, 49152
  buffer_load_dwordx4 v2, s[28:31], s60 offen sc1 lds
  buffer_load_dwordx4 v2, s[28:31], s60 offen offset:1024 sc1 lds
  v_exp_f32 v85, v85
  v_exp_f32 v86, v86
  v_exp_f32 v87, v87
  v_exp_f32 v88, v88
  v_exp_f32 v89, v89
  v_exp_f32 v90, v90
  s_waitcnt lgkmcnt(2)
  v_smfmac_f32_32x32x32_bf16 v[48:63], v[100:103], v[80:87], v13
  ds_read_b128 v[100:103], v15 offset:4160
  v_exp_f32 v91, v91
  v_exp_f32 v92, v92
  v_exp_f32 v93, v93
  v_exp_f32 v94, v94
  v_exp_f32 v95, v95
  s_waitcnt lgkmcnt(1)
  v_mfma_f32_32x32x16_bf16 v[64:79], v[96:99], v[28:31], v[32:47]
  ds_read_b128 v[96:99], v14 offset:8320
  v_exp_f32 v112, v112
  v_exp_f32 v113, v113
  v_exp_f32 v114, v114
  v_exp_f32 v115, v115
  v_exp_f32 v116, v116
  v_smfmac_f32_32x32x32_bf16 v[48:63], v[104:107], v[88:95], v13
  ds_read_b128 v[104:107], v16 offset:4160
  s_add_u32 m0, s65, 66560
  s_add_u32 s60, s62, 65536
  buffer_load_dwordx4 v2, s[28:31], s60 offen sc1 lds
  buffer_load_dwordx4 v2, s[28:31], s60 offen offset:1024 sc1 lds
  v_exp_f32 v117, v117
  v_exp_f32 v118, v118
  v_exp_f32 v119, v119
  v_exp_f32 v120, v120
  v_exp_f32 v121, v121
  v_exp_f32 v122, v122
  s_waitcnt lgkmcnt(2)
  v_smfmac_f32_32x32x32_bf16 v[48:63], v[100:103], v[112:119], v13
  ds_read_b128 v[100:103], v15 offset:6240
  v_exp_f32 v123, v123
  v_exp_f32 v124, v124
  v_exp_f32 v125, v125
  v_exp_f32 v126, v126
  v_exp_f32 v127, v127
  s_waitcnt lgkmcnt(1)
  v_mfma_f32_32x32x16_bf16 v[80:95], v[96:99], v[28:31], v[32:47]
  ds_read_b128 v[96:99], v14 offset:10400
  v_exp_f32 v64, v64
  v_exp_f32 v65, v65
  v_exp_f32 v66, v66
  v_exp_f32 v67, v67
  v_exp_f32 v68, v68
  v_smfmac_f32_32x32x32_bf16 v[48:63], v[104:107], v[120:127], v13
  ds_read_b128 v[104:107], v16 offset:6240
  s_add_u32 m0, s65, 83200
  s_add_u32 s60, s62, 81920
  buffer_load_dwordx4 v2, s[28:31], s60 offen sc1 lds
  buffer_load_dwordx4 v2, s[28:31], s60 offen offset:1024 sc1 lds
  v_exp_f32 v69, v69
  v_exp_f32 v70, v70
  v_exp_f32 v71, v71
  v_exp_f32 v72, v72
  v_exp_f32 v73, v73
  v_exp_f32 v74, v74
  s_waitcnt lgkmcnt(2)
  v_smfmac_f32_32x32x32_bf16 v[48:63], v[100:103], v[64:71], v13
  ds_read_b128 v[100:103], v15 offset:8320
  v_exp_f32 v75, v75
  v_exp_f32 v76, v76
  v_exp_f32 v77, v77
  v_exp_f32 v78, v78
  v_exp_f32 v79, v79
  s_waitcnt lgkmcnt(1)
  v_mfma_f32_32x32x16_bf16 v[112:127], v[96:99], v[28:31], v[32:47]
  ds_read_b128 v[96:99], v14 offset:12480
  v_exp_f32 v80, v80
  v_exp_f32 v81, v81
  v_exp_f32 v82, v82
  v_exp_f32 v83, v83
  v_exp_f32 v84, v84
  v_smfmac_f32_32x32x32_bf16 v[48:63], v[104:107], v[72:79], v13
  ds_read_b128 v[104:107], v16 offset:8320
  s_add_u32 m0, s65, 99840
  s_add_u32 s60, s62, 98304
  buffer_load_dwordx4 v2, s[28:31], s60 offen sc1 lds
  buffer_load_dwordx4 v2, s[28:31], s60 offen offset:1024 sc1 lds
  v_exp_f32 v85, v85
  v_exp_f32 v86, v86
  v_exp_f32 v87, v87
  v_exp_f32 v88, v88
  v_exp_f32 v89, v89
  v_exp_f32 v90, v90
  s_waitcnt lgkmcnt(2)
  v_smfmac_f32_32x32x32_bf16 v[48:63], v[100:103], v[80:87], v13
  ds_read_b128 v[100:103], v15 offset:10400
  v_exp_f32 v91, v91
  v_exp_f32 v92, v92
  v_exp_f32 v93, v93
  v_exp_f32 v94, v94
  v_exp_f32 v95, v95
  s_waitcnt lgkmcnt(1)
  v_mfma_f32_32x32x16_bf16 v[64:79], v[96:99], v[28:31], v[32:47]
  ds_read_b128 v[96:99], v14 offset:14560
  v_exp_f32 v112, v112
  v_exp_f32 v113, v113
  v_exp_f32 v114, v114
  v_exp_f32 v115, v115
  v_exp_f32 v116, v116
  v_smfmac_f32_32x32x32_bf16 v[48:63], v[104:107], v[88:95], v13
  ds_read_b128 v[104:107], v16 offset:10400
  s_add_u32 m0, s65, 116480
  s_add_u32 s60, s62, 114688
  buffer_load_dwordx4 v2, s[28:31], s60 offen sc1 lds
  buffer_load_dwordx4 v2, s[28:31], s60 offen offset:1024 sc1 lds
  v_exp_f32 v117, v117
  v_exp_f32 v118, v118
  v_exp_f32 v119, v119
  v_exp_f32 v120, v120
  v_exp_f32 v121, v121
  v_exp_f32 v122, v122
  s_waitcnt lgkmcnt(2)
  v_smfmac_f32_32x32x32_bf16 v[48:63], v[100:103], v[112:119], v13
  ds_read_b128 v[100:103], v15 offset:12480
  v_exp_f32 v123, v123
  v_exp_f32 v124, v124
  v_exp_f32 v125, v125
  v_exp_f32 v126, v126
  v_exp_f32 v127, v127
  s_waitcnt lgkmcnt(1)
  v_mfma_f32_32x32x16_bf16 v[80:95], v[96:99], v[28:31], v[32:47]
  ds_read_b128 v[96:99], v14 offset:16640
  v_exp_f32 v64, v64
  v_exp_f32 v65, v65
  v_exp_f32 v66, v66
  v_exp_f32 v67, v67
  v_exp_f32 v68, v68
  v_smfmac_f32_32x32x32_bf16 v[48:63], v[104:107], v[120:127], v13
  ds_read_b128 v[104:107], v16 offset:12480
  s_add_u32 m0, s52, 147456
  s_nop 0
  buffer_load_dwordx4 v5, s[24:27], s6 offen lds
  v_and_b32 v5, 31, v1
  v_exp_f32 v69, v69
  v_exp_f32 v70, v70
  v_exp_f32 v71, v71
  v_exp_f32 v72, v72
  v_exp_f32 v73, v73
  v_exp_f32 v74, v74
  s_waitcnt lgkmcnt(2)
  v_smfmac_f32_32x32x32_bf16 v[48:63], v[100:103], v[64:71], v13
  ds_read_b128 v[100:103], v15 offset:14560
  v_exp_f32 v75, v75
  v_exp_f32 v76, v76
  v_exp_f32 v77, v77
  v_exp_f32 v78, v78
  v_exp_f32 v79, v79
  s_waitcnt lgkmcnt(1)
  v_mfma_f32_32x32x16_bf16 v[112:127], v[96:99], v[28:31], v[32:47]
  ds_read_b128 v[96:99], v14 offset:18720
  v_exp_f32 v80, v80
  v_exp_f32 v81, v81
  v_exp_f32 v82, v82
  v_exp_f32 v83, v83
  v_exp_f32 v84, v84
  v_smfmac_f32_32x32x32_bf16 v[48:63], v[104:107], v[72:79], v13
  ds_read_b128 v[104:107], v16 offset:14560
  buffer_store_dwordx4 v[136:139], v2, s[28:31], s0 offen sc1
  buffer_store_dwordx4 v[140:143], v2, s[28:31], s0 offen offset:1024 sc1
  buffer_store_dwordx4 v[128:131], v2, s[28:31], s14 offen sc1
  v_exp_f32 v85, v85
  v_exp_f32 v86, v86
  v_exp_f32 v87, v87
  v_exp_f32 v88, v88
  v_exp_f32 v89, v89
  v_exp_f32 v90, v90
  s_waitcnt lgkmcnt(2)
  v_smfmac_f32_32x32x32_bf16 v[48:63], v[100:103], v[80:87], v13
  ds_read_b128 v[100:103], v15 offset:16640
  v_exp_f32 v91, v91
  v_exp_f32 v92, v92
  v_exp_f32 v93, v93
  v_exp_f32 v94, v94
  v_exp_f32 v95, v95
  s_waitcnt lgkmcnt(1)
  v_mfma_f32_32x32x16_bf16 v[64:79], v[96:99], v[28:31], v[32:47]
  ds_read_b128 v[96:99], v14 offset:20800
  v_exp_f32 v112, v112
  v_exp_f32 v113, v113
  v_exp_f32 v114, v114
  v_exp_f32 v115, v115
  v_exp_f32 v116, v116
  v_smfmac_f32_32x32x32_bf16 v[48:63], v[104:107], v[88:95], v13
  ds_read_b128 v[104:107], v16 offset:16640
  v_exp_f32 v117, v117
  v_exp_f32 v118, v118
  v_exp_f32 v119, v119
  v_exp_f32 v120, v120
  v_exp_f32 v121, v121
  v_exp_f32 v122, v122
  s_waitcnt lgkmcnt(2)
  v_smfmac_f32_32x32x32_bf16 v[48:63], v[100:103], v[112:119], v13
  ds_read_b128 v[100:103], v15 offset:18720
  v_exp_f32 v123, v123
  v_exp_f32 v124, v124
  v_exp_f32 v125, v125
  v_exp_f32 v126, v126
  v_exp_f32 v127, v127
  s_waitcnt lgkmcnt(1)
  v_mfma_f32_32x32x16_bf16 v[80:95], v[96:99], v[28:31], v[32:47]
  ds_read_b128 v[96:99], v14 offset:22880
  v_exp_f32 v64, v64
  v_exp_f32 v65, v65
  v_exp_f32 v66, v66
  v_exp_f32 v67, v67
  v_exp_f32 v68, v68
  v_smfmac_f32_32x32x32_bf16 v[48:63], v[104:107], v[120:127], v13
  ds_read_b128 v[104:107], v16 offset:18720
  v_exp_f32 v69, v69
  v_exp_f32 v70, v70
  v_exp_f32 v71, v71
  v_exp_f32 v72, v72
  v_exp_f32 v73, v73
  v_exp_f32 v74, v74
  s_waitcnt lgkmcnt(2)
  v_smfmac_f32_32x32x32_bf16 v[48:63], v[100:103], v[64:71], v13
  ds_read_b128 v[100:103], v15 offset:20800
  v_exp_f32 v75, v75
  v_exp_f32 v76, v76
  v_exp_f32 v77, v77
  v_exp_f32 v78, v78
  v_exp_f32 v79, v79
  s_setprio 2
  s_waitcnt lgkmcnt(1)
  v_mfma_f32_32x32x16_bf16 v[112:127], v[96:99], v[28:31], v[32:47]
  ds_read_b128 v[96:99], v14 offset:24960
  v_exp_f32 v80, v80
  v_exp_f32 v81, v81
  v_exp_f32 v82, v82
  v_exp_f32 v83, v83
  v_exp_f32 v84, v84
  v_smfmac_f32_32x32x32_bf16 v[48:63], v[104:107], v[72:79], v13
  ds_read_b128 v[104:107], v16 offset:20800
  v_exp_f32 v85, v85
  v_exp_f32 v86, v86
  v_exp_f32 v87, v87
  v_exp_f32 v88, v88
  v_exp_f32 v89, v89
  v_exp_f32 v90, v90
  s_waitcnt lgkmcnt(2)
  v_smfmac_f32_32x32x32_bf16 v[48:63], v[100:103], v[80:87], v13
  ds_read_b128 v[100:103], v15 offset:22880
  v_exp_f32 v91, v91
  v_exp_f32 v92, v92
  v_exp_f32 v93, v93
  v_exp_f32 v94, v94
  v_exp_f32 v95, v95
  s_waitcnt lgkmcnt(1)
  v_mfma_f32_32x32x16_bf16 v[64:79], v[96:99], v[28:31], v[32:47]
  ds_read_b128 v[96:99], v14 offset:27040
  v_exp_f32 v112, v112
  v_exp_f32 v113, v113
  v_exp_f32 v114, v114
  v_exp_f32 v115, v115
  v_exp_f32 v116, v116
  v_smfmac_f32_32x32x32_bf16 v[48:63], v[104:107], v[88:95], v13
  ds_read_b128 v[104:107], v16 offset:22880
  v_exp_f32 v117, v117
  v_exp_f32 v118, v118
  v_exp_f32 v119, v119
  v_exp_f32 v120, v120
  v_exp_f32 v121, v121
  v_exp_f32 v122, v122
  s_waitcnt lgkmcnt(2)
  v_smfmac_f32_32x32x32_bf16 v[48:63], v[100:103], v[112:119], v13
  ds_read_b128 v[100:103], v15 offset:24960
  v_exp_f32 v123, v123
  v_exp_f32 v124, v124
  v_exp_f32 v125, v125
  v_exp_f32 v126, v126
  v_exp_f32 v127, v127
  s_waitcnt lgkmcnt(1)
  v_mfma_f32_32x32x16_bf16 v[80:95], v[96:99], v[28:31], v[32:47]
  ds_read_b128 v[96:99], v14 offset:29120
  v_exp_f32 v64, v64
  v_exp_f32 v65, v65
  v_exp_f32 v66, v66
  v_exp_f32 v67, v67
  v_exp_f32 v68, v68
  v_smfmac_f32_32x32x32_bf16 v[48:63], v[104:107], v[120:127], v13
  ds_read_b128 v[104:107], v16 offset:24960
  v_exp_f32 v69, v69
  v_exp_f32 v70, v70
  v_exp_f32 v71, v71
  v_exp_f32 v72, v72
  v_exp_f32 v73, v73
  v_exp_f32 v74, v74
  s_waitcnt lgkmcnt(2)
  v_smfmac_f32_32x32x32_bf16 v[48:63], v[100:103], v[64:71], v13
  ds_read_b128 v[100:103], v15 offset:27040
  v_exp_f32 v75, v75
  v_exp_f32 v76, v76
  v_exp_f32 v77, v77
  v_exp_f32 v78, v78
  v_exp_f32 v79, v79
  s_waitcnt lgkmcnt(1)
  v_mfma_f32_32x32x16_bf16 v[112:127], v[96:99], v[28:31], v[32:47]
  ds_read_b128 v[96:99], v14 offset:31200
  v_exp_f32 v80, v80
  v_exp_f32 v81, v81
  v_exp_f32 v82, v82
  v_exp_f32 v83, v83
  v_exp_f32 v84, v84
  v_smfmac_f32_32x32x32_bf16 v[48:63], v[104:107], v[72:79], v13
  ds_read_b128 v[104:107], v16 offset:27040
  v_exp_f32 v85, v85
  v_exp_f32 v86, v86
  v_exp_f32 v87, v87
  v_exp_f32 v88, v88
  v_exp_f32 v89, v89
  v_exp_f32 v90, v90
  s_waitcnt lgkmcnt(2)
  v_smfmac_f32_32x32x32_bf16 v[48:63], v[100:103], v[80:87], v13
  ds_read_b128 v[100:103], v15 offset:29120
  v_exp_f32 v91, v91
  v_exp_f32 v92, v92
  v_exp_f32 v93, v93
  v_exp_f32 v94, v94
  v_exp_f32 v95, v95
  s_waitcnt vmcnt(4)
  s_barrier
  s_setprio 3
  s_waitcnt lgkmcnt(1)
  v_mfma_f32_32x32x16_bf16 v[64:79], v[96:99], v[28:31], v[32:47]
  ds_read_b128 v[96:99], v14 offset:33280
  v_exp_f32 v112, v112
  v_exp_f32 v113, v113
  v_exp_f32 v114, v114
  v_exp_f32 v115, v115
  v_exp_f32 v116, v116
  v_smfmac_f32_32x32x32_bf16 v[48:63], v[104:107], v[88:95], v13
  ds_read_b128 v[104:107], v16 offset:29120
  s_waitcnt vmcnt(3)
  ds_read_b64_tr_b16 v[132:133], v26
  ds_read_b64_tr_b16 v[134:135], v26 offset:512
  v_exp_f32 v117, v117
  v_exp_f32 v118, v118
  v_exp_f32 v119, v119
  v_exp_f32 v120, v120
  v_exp_f32 v121, v121
  v_exp_f32 v122, v122
  s_waitcnt lgkmcnt(4)
  v_smfmac_f32_32x32x32_bf16 v[48:63], v[100:103], v[112:119], v13
  ds_read_b128 v[100:103], v15 offset:31200
  v_exp_f32 v123, v123
  v_exp_f32 v124, v124
  v_exp_f32 v125, v125
  v_exp_f32 v126, v126
  v_exp_f32 v127, v127
  s_waitcnt lgkmcnt(3)
  v_mfma_f32_32x32x16_bf16 v[80:95], v[96:99], v[28:31], v[32:47]
  ds_read_b128 v[96:99], v14 offset:35360
  v_exp_f32 v64, v64
  v_exp_f32 v65, v65
  v_exp_f32 v66, v66
  v_exp_f32 v67, v67
  v_exp_f32 v68, v68
  v_smfmac_f32_32x32x32_bf16 v[48:63], v[104:107], v[120:127], v13
  ds_read_b128 v[104:107], v16 offset:31200
  s_waitcnt lgkmcnt(3)
  buffer_store_dwordx4 v[132:135], v2, s[28:31], s64 offen sc1
  v_exp_f32 v69, v69
  v_exp_f32 v70, v70
  v_exp_f32 v71, v71
  v_exp_f32 v72, v72
  v_exp_f32 v73, v73
  v_exp_f32 v74, v74
  s_waitcnt lgkmcnt(2)
  v_smfmac_f32_32x32x32_bf16 v[48:63], v[100:103], v[64:71], v13
  ds_read_b128 v[100:103], v15 offset:33280
  v_exp_f32 v75, v75
  v_exp_f32 v76, v76
  v_exp_f32 v77, v77
  v_exp_f32 v78, v78
  v_exp_f32 v79, v79
  s_waitcnt lgkmcnt(1)
  v_mfma_f32_32x32x16_bf16 v[112:127], v[96:99], v[28:31], v[32:47]
  ds_read_b128 v[96:99], v14 offset:37440
  v_exp_f32 v80, v80
  v_exp_f32 v81, v81
  v_exp_f32 v82, v82
  v_exp_f32 v83, v83
  v_exp_f32 v84, v84
  v_smfmac_f32_32x32x32_bf16 v[48:63], v[104:107], v[72:79], v13
  ds_read_b128 v[104:107], v16 offset:33280
  v_exp_f32 v85, v85
  v_exp_f32 v86, v86
  v_exp_f32 v87, v87
  v_exp_f32 v88, v88
  v_exp_f32 v89, v89
  v_exp_f32 v90, v90
  s_waitcnt lgkmcnt(2)
  v_smfmac_f32_32x32x32_bf16 v[48:63], v[100:103], v[80:87], v13
  ds_read_b128 v[100:103], v15 offset:35360
  v_exp_f32 v91, v91
  v_exp_f32 v92, v92
  v_exp_f32 v93, v93
  v_exp_f32 v94, v94
  v_exp_f32 v95, v95
  s_waitcnt lgkmcnt(1)
  v_mfma_f32_32x32x16_bf16 v[64:79], v[96:99], v[28:31], v[32:47]
  ds_read_b128 v[96:99], v14 offset:39520
  v_exp_f32 v112, v112
  v_exp_f32 v113, v113
  v_exp_f32 v114, v114
  v_exp_f32 v115, v115
  v_exp_f32 v116, v116
  v_smfmac_f32_32x32x32_bf16 v[48:63], v[104:107], v[88:95], v13
  ds_read_b128 v[104:107], v16 offset:35360
  v_exp_f32 v117, v117
  v_exp_f32 v118, v118
  v_exp_f32 v119, v119
  v_exp_f32 v120, v120
  v_exp_f32 v121, v121
  v_exp_f32 v122, v122
  s_waitcnt lgkmcnt(2)
  v_smfmac_f32_32x32x32_bf16 v[48:63], v[100:103], v[112:119], v13
  ds_read_b128 v[100:103], v15 offset:37440
  v_exp_f32 v123, v123
  v_exp_f32 v124, v124
  v_exp_f32 v125, v125
  v_exp_f32 v126, v126
  v_exp_f32 v127, v127
  s_waitcnt lgkmcnt(1)
  v_mfma_f32_32x32x16_bf16 v[80:95], v[96:99], v[28:31], v[32:47]
  ds_read_b128 v[96:99], v14 offset:41600
  v_exp_f32 v64, v64
  v_exp_f32 v65, v65
  v_exp_f32 v66, v66
  v_exp_f32 v67, v67
  v_exp_f32 v68, v68
  v_smfmac_f32_32x32x32_bf16 v[48:63], v[104:107], v[120:127], v13
  ds_read_b128 v[104:107], v16 offset:37440
  v_exp_f32 v69, v69
  v_exp_f32 v70, v70
  v_exp_f32 v71, v71
  v_exp_f32 v72, v72
  v_exp_f32 v73, v73
  v_exp_f32 v74, v74
  s_waitcnt lgkmcnt(2)
  v_smfmac_f32_32x32x32_bf16 v[48:63], v[100:103], v[64:71], v13
  ds_read_b128 v[100:103], v15 offset:39520
  s_waitcnt vmcnt(0)
  v_mov_b32 v0, 1
  s_mov_b64 exec, 1
  ds_add_rtn_u32 v0, v25, v0 offset:4
  s_mov_b64 exec, -1
  v_exp_f32 v75, v75
  v_exp_f32 v76, v76
  v_exp_f32 v77, v77
  v_exp_f32 v78, v78
  v_exp_f32 v79, v79
  s_waitcnt lgkmcnt(2)
  v_mfma_f32_32x32x16_bf16 v[112:127], v[96:99], v[28:31], v[32:47]
  ds_read_b128 v[96:99], v14 offset:43680
  v_exp_f32 v80, v80
  v_exp_f32 v81, v81
  v_exp_f32 v82, v82
  v_exp_f32 v83, v83
  v_exp_f32 v84, v84
  v_smfmac_f32_32x32x32_bf16 v[48:63], v[104:107], v[72:79], v13
  ds_read_b128 v[104:107], v16 offset:39520
  v_exp_f32 v85, v85
  v_exp_f32 v86, v86
  v_exp_f32 v87, v87
  v_exp_f32 v88, v88
  v_exp_f32 v89, v89
  v_exp_f32 v90, v90
  s_waitcnt lgkmcnt(3)
  v_smfmac_f32_32x32x32_bf16 v[48:63], v[100:103], v[80:87], v13
  ds_read_b128 v[100:103], v15 offset:41600
  s_waitcnt lgkmcnt(3)
  v_readfirstlane_b32 s56, v0
  s_lshl_b32 s57, s2, 2
  s_add_u32 s57, s57, 10485760
  s_cmp_lg_u32 s56, 7
  s_cbranch_scc1 Lnofob
  s_mov_b64 exec, 1
  buffer_store_dword v21, v20, s[28:31], s57 offen sc1
  s_mov_b64 exec, -1
Lnofob:
  v_exp_f32 v91, v91
  v_exp_f32 v92, v92
  v_exp_f32 v93, v93
  v_exp_f32 v94, v94
  v_exp_f32 v95, v95
  s_setprio 2
  s_waitcnt lgkmcnt(1)
  v_mfma_f32_32x32x16_bf16 v[64:79], v[96:99], v[28:31], v[32:47]
  ds_read_b128 v[96:99], v14 offset:45760
  v_exp_f32 v112, v112
  v_exp_f32 v113, v113
  v_exp_f32 v114, v114
  v_exp_f32 v115, v115
  v_exp_f32 v116, v116
  v_smfmac_f32_32x32x32_bf16 v[48:63], v[104:107], v[88:95], v13
  ds_read_b128 v[104:107], v16 offset:41600
  v_exp_f32 v117, v117
  v_exp_f32 v118, v118
  v_exp_f32 v119, v119
  v_exp_f32 v120, v120
  v_exp_f32 v121, v121
  v_exp_f32 v122, v122
  s_waitcnt lgkmcnt(2)
  v_smfmac_f32_32x32x32_bf16 v[48:63], v[100:103], v[112:119], v13
  ds_read_b128 v[100:103], v15 offset:43680
  v_exp_f32 v123, v123
  v_exp_f32 v124, v124
  v_exp_f32 v125, v125
  v_exp_f32 v126, v126
  v_exp_f32 v127, v127
  s_waitcnt lgkmcnt(1)
  v_mfma_f32_32x32x16_bf16 v[80:95], v[96:99], v[28:31], v[32:47]
  ds_read_b128 v[96:99], v14 offset:47840
  v_exp_f32 v64, v64
  v_exp_f32 v65, v65
  v_exp_f32 v66, v66
  v_exp_f32 v67, v67
  v_exp_f32 v68, v68
  v_smfmac_f32_32x32x32_bf16 v[48:63], v[104:107], v[120:127], v13
  ds_read_b128 v[104:107], v16 offset:43680
  v_exp_f32 v69, v69
  v_exp_f32 v70, v70
  v_exp_f32 v71, v71
  v_exp_f32 v72, v72
  v_exp_f32 v73, v73
  v_exp_f32 v74, v74
  s_waitcnt lgkmcnt(2)
  v_smfmac_f32_32x32x32_bf16 v[48:63], v[100:103], v[64:71], v13
  ds_read_b128 v[100:103], v15 offset:45760
  v_exp_f32 v75, v75
  v_exp_f32 v76, v76
  v_exp_f32 v77, v77
  v_exp_f32 v78, v78
  v_exp_f32 v79, v79
  s_waitcnt lgkmcnt(1)
  v_mfma_f32_32x32x16_bf16 v[112:127], v[96:99], v[28:31], v[32:47]
  ds_read_b128 v[96:99], v14 offset:49920
  v_exp_f32 v80, v80
  v_exp_f32 v81, v81
  v_exp_f32 v82, v82
  v_exp_f32 v83, v83
  v_exp_f32 v84, v84
  v_smfmac_f32_32x32x32_bf16 v[48:63], v[104:107], v[72:79], v13
  ds_read_b128 v[104:107], v16 offset:45760
  v_exp_f32 v85, v85
  v_exp_f32 v86, v86
  v_exp_f32 v87, v87
  v_exp_f32 v88, v88
  v_exp_f32 v89, v89
  v_exp_f32 v90, v90
  s_waitcnt lgkmcnt(2)
  v_smfmac_f32_32x32x32_bf16 v[48:63], v[100:103], v[80:87], v13
  ds_read_b128 v[100:103], v15 offset:47840
  v_exp_f32 v91, v91
  v_exp_f32 v92, v92
  v_exp_f32 v93, v93
  v_exp_f32 v94, v94
  v_exp_f32 v95, v95
  s_waitcnt lgkmcnt(1)
  v_mfma_f32_32x32x16_bf16 v[64:79], v[96:99], v[28:31], v[32:47]
  ds_read_b128 v[96:99], v14 offset:52000
  v_exp_f32 v112, v112
  v_exp_f32 v113, v113
  v_exp_f32 v114, v114
  v_exp_f32 v115, v115
  v_exp_f32 v116, v116
  v_smfmac_f32_32x32x32_bf16 v[48:63], v[104:107], v[88:95], v13
  ds_read_b128 v[104:107], v16 offset:47840
  v_exp_f32 v117, v117
  v_exp_f32 v118, v118
  v_exp_f32 v119, v119
  v_exp_f32 v120, v120
  v_exp_f32 v121, v121
  v_exp_f32 v122, v122
  s_waitcnt lgkmcnt(2)
  v_smfmac_f32_32x32x32_bf16 v[48:63], v[100:103], v[112:119], v13
  ds_read_b128 v[100:103], v15 offset:49920
  v_exp_f32 v123, v123
  v_exp_f32 v124, v124
  v_exp_f32 v125, v125
  v_exp_f32 v126, v126
  v_exp_f32 v127, v127
  v_add_u32 v14, 49920, v14
  v_add_u32 v15, 49920, v15
  v_add_u32 v16, 49920, v16
  s_waitcnt lgkmcnt(1)
  v_mfma_f32_32x32x16_bf16 v[80:95], v[96:99], v[28:31], v[32:47]
  ds_read_b128 v[96:99], v14 offset:4160
  v_exp_f32 v64, v64
  v_exp_f32 v65, v65
  v_exp_f32 v66, v66
  v_exp_f32 v67, v67
  v_exp_f32 v68, v68
  v_smfmac_f32_32x32x32_bf16 v[48:63], v[104:107], v[120:127], v13
  ds_read_b128 v[104:107], v16 offset:0
  v_exp_f32 v69, v69
  v_exp_f32 v70, v70
  v_exp_f32 v71, v71
  v_exp_f32 v72, v72
  v_exp_f32 v73, v73
  v_exp_f32 v74, v74
  s_waitcnt lgkmcnt(2)
  v_smfmac_f32_32x32x32_bf16 v[48:63], v[100:103], v[64:71], v13
  ds_read_b128 v[100:103], v15 offset:2080
  v_exp_f32 v75, v75
  v_exp_f32 v76, v76
  v_exp_f32 v77, v77
  v_exp_f32 v78, v78
  v_exp_f32 v79, v79
  s_waitcnt lgkmcnt(1)
  v_mfma_f32_32x32x16_bf16 v[112:127], v[96:99], v[28:31], v[32:47]
  ds_read_b128 v[96:99], v14 offset:6240
  v_exp_f32 v80, v80
  v_exp_f32 v81, v81
  v_exp_f32 v82, v82
  v_exp_f32 v83, v83
  v_exp_f32 v84, v84
  v_smfmac_f32_32x32x32_bf16 v[48:63], v[104:107], v[72:79], v13
  ds_read_b128 v[104:107], v16 offset:2080
  v_exp_f32 v85, v85
  v_exp_f32 v86, v86
  v_exp_f32 v87, v87
  v_exp_f32 v88, v88
  v_exp_f32 v89, v89
  v_exp_f32 v90, v90
  s_waitcnt lgkmcnt(2)
  v_smfmac_f32_32x32x32_bf16 v[48:63], v[100:103], v[80:87], v13
  ds_read_b128 v[100:103], v15 offset:4160
  v_exp_f32 v91, v91
  v_exp_f32 v92, v92
  v_exp_f32 v93, v93
  v_exp_f32 v94, v94
  v_exp_f32 v95, v95
  s_waitcnt lgkmcnt(1)
  v_mfma_f32_32x32x16_bf16 v[64:79], v[96:99], v[28:31], v[32:47]
  ds_read_b128 v[96:99], v14 offset:8320
  v_exp_f32 v112, v112
  v_exp_f32 v113, v113
  v_exp_f32 v114, v114
  v_exp_f32 v115, v115
  v_exp_f32 v116, v116
  v_smfmac_f32_32x32x32_bf16 v[48:63], v[104:107], v[88:95], v13
  ds_read_b128 v[104:107], v16 offset:4160
  s_lshl_b32 s56, s41, 2
  s_add_u32 s56, s56, s43
  s_lshl_b32 s59, s56, 16
  s_lshl_b32 s58, s40, 12
  s_add_u32 s59, s59, s58
  s_add_u32 s62, s59, 6291456
  v_add_u32 v26, s58, v2
  s_lshl_b32 s59, s47, 14
  v_add_u32 v18, s59, v2
  s_lshl_b32 s59, s48, 12
  s_add_u32 s59, s59, 65536
  v_add_u32 v19, s59, v2
  v_lshlrev_b32 v11, 10, v5
  v_lshl_add_u32 v11, v3, 4, v11
  s_lshl_b32 s56, s56, 15
  s_lshl_b32 s59, s44, 8
  s_add_u32 s56, s56, s59
  s_lshl_b32 s59, s48, 6
  s_add_u32 s56, s56, s59
  s_lshl_b32 s59, s47, 5
  s_add_u32 s64, s56, s59
  s_mul_i32 s59, s47, 2080
  s_add_u32 s59, s59, 101904
  v_and_b32 v6, 3, v1
  v_lshl_add_u32 v6, v6, 2, s59
  s_lshl_b32 s58, s48, 2
  s_add_u32 s59, s59, s58
  v_mov_b32 v4, s59
  s_mul_i32 s59, s47, 15360
  s_add_u32 s59, s59, 133120
  v_add_u32 v12, s59, v2
  s_lshl_b32 s58, s48, 12
  s_add_u32 s95, s59, s58
  s_add_u32 s0, s50, s58
  v_exp_f32 v117, v117
  v_exp_f32 v118, v118
  v_exp_f32 v119, v119
  v_exp_f32 v120, v120
  v_exp_f32 v121, v121
  v_exp_f32 v122, v122
  s_waitcnt lgkmcnt(2)
  v_smfmac_f32_32x32x32_bf16 v[48:63], v[100:103], v[112:119], v13
  ds_read_b128 v[100:103], v15 offset:6240
  v_exp_f32 v123, v123
  v_exp_f32 v124, v124
  v_exp_f32 v125, v125
  v_exp_f32 v126, v126
  v_exp_f32 v127, v127
  s_waitcnt lgkmcnt(1)
  v_mfma_f32_32x32x16_bf16 v[80:95], v[96:99], v[28:31], v[32:47]
  ds_read_b128 v[96:99], v14 offset:10400
  v_exp_f32 v64, v64
  v_exp_f32 v65, v65
  v_exp_f32 v66, v66
  v_exp_f32 v67, v67
  v_exp_f32 v68, v68
  v_smfmac_f32_32x32x32_bf16 v[48:63], v[104:107], v[120:127], v13
  ds_read_b128 v[104:107], v16 offset:6240
  v_exp_f32 v69, v69
  v_exp_f32 v70, v70
  v_exp_f32 v71, v71
  v_exp_f32 v72, v72
  v_exp_f32 v73, v73
  v_exp_f32 v74, v74
  s_waitcnt lgkmcnt(2)
  v_smfmac_f32_32x32x32_bf16 v[48:63], v[100:103], v[64:71], v13
  ds_read_b128 v[100:103], v15 offset:8320
  v_exp_f32 v75, v75
  v_exp_f32 v76, v76
  v_exp_f32 v77, v77
  v_exp_f32 v78, v78
  v_exp_f32 v79, v79
  s_waitcnt lgkmcnt(1)
  v_mfma_f32_32x32x16_bf16 v[112:127], v[96:99], v[28:31], v[32:47]
  ds_read_b128 v[96:99], v14 offset:12480
  v_exp_f32 v80, v80
  v_exp_f32 v81, v81
  v_exp_f32 v82, v82
  v_exp_f32 v83, v83
  v_exp_f32 v84, v84
  v_smfmac_f32_32x32x32_bf16 v[48:63], v[104:107], v[72:79], v13
  ds_read_b128 v[104:107], v16 offset:8320
  v_exp_f32 v85, v85
  v_exp_f32 v86, v86
  v_exp_f32 v87, v87
  v_exp_f32 v88, v88
  v_exp_f32 v89, v89
  v_exp_f32 v90, v90
  s_waitcnt lgkmcnt(2)
  v_smfmac_f32_32x32x32_bf16 v[48:63], v[100:103], v[80:87], v13
  ds_read_b128 v[100:103], v15 offset:10400
  v_exp_f32 v91, v91
  v_exp_f32 v92, v92
  v_exp_f32 v93, v93
  v_exp_f32 v94, v94
  v_exp_f32 v95, v95
  s_waitcnt lgkmcnt(1)
  v_mfma_f32_32x32x16_bf16 v[64:79], v[96:99], v[28:31], v[32:47]
  ds_read_b128 v[96:99], v14 offset:14560
  v_exp_f32 v112, v112
  v_exp_f32 v113, v113
  v_exp_f32 v114, v114
  v_exp_f32 v115, v115
  v_exp_f32 v116, v116
  v_smfmac_f32_32x32x32_bf16 v[48:63], v[104:107], v[88:95], v13
  ds_read_b128 v[104:107], v16 offset:10400
  v_exp_f32 v117, v117
  v_exp_f32 v118, v118
  v_exp_f32 v119, v119
  v_exp_f32 v120, v120
  v_exp_f32 v121, v121
  v_exp_f32 v122, v122
  s_waitcnt lgkmcnt(2)
  v_smfmac_f32_32x32x32_bf16 v[48:63], v[100:103], v[112:119], v13
  ds_read_b128 v[100:103], v15 offset:12480
  v_exp_f32 v123, v123
  v_exp_f32 v124, v124
  v_exp_f32 v125, v125
  v_exp_f32 v126, v126
  v_exp_f32 v127, v127
  s_waitcnt lgkmcnt(1)
  v_mfma_f32_32x32x16_bf16 v[80:95], v[96:99], v[28:31], v[32:47]
  ds_read_b128 v[96:99], v14 offset:16640
  v_exp_f32 v64, v64
  v_exp_f32 v65, v65
  v_exp_f32 v66, v66
  v_exp_f32 v67, v67
  v_exp_f32 v68, v68
  v_smfmac_f32_32x32x32_bf16 v[48:63], v[104:107], v[120:127], v13
  ds_read_b128 v[104:107], v16 offset:12480
  v_exp_f32 v69, v69
  v_exp_f32 v70, v70
  v_exp_f32 v71, v71
  v_exp_f32 v72, v72
  v_exp_f32 v73, v73
  v_exp_f32 v74, v74
  s_waitcnt lgkmcnt(2)
  v_smfmac_f32_32x32x32_bf16 v[48:63], v[100:103], v[64:71], v13
  ds_read_b128 v[100:103], v15 offset:14560
  v_exp_f32 v75, v75
  v_exp_f32 v76, v76
  v_exp_f32 v77, v77
  v_exp_f32 v78, v78
  v_exp_f32 v79, v79
  s_waitcnt lgkmcnt(1)
  v_mfma_f32_32x32x16_bf16 v[112:127], v[96:99], v[28:31], v[32:47]
  ds_read_b128 v[96:99], v14 offset:18720
  v_exp_f32 v80, v80
  v_exp_f32 v81, v81
  v_exp_f32 v82, v82
  v_exp_f32 v83, v83
  v_exp_f32 v84, v84
  v_smfmac_f32_32x32x32_bf16 v[48:63], v[104:107], v[72:79], v13
  ds_read_b128 v[104:107], v16 offset:14560
  v_exp_f32 v85, v85
  v_exp_f32 v86, v86
  v_exp_f32 v87, v87
  v_exp_f32 v88, v88
  v_exp_f32 v89, v89
  v_exp_f32 v90, v90
  s_waitcnt lgkmcnt(2)
  v_smfmac_f32_32x32x32_bf16 v[48:63], v[100:103], v[80:87], v13
  ds_read_b128 v[100:103], v15 offset:16640
  v_exp_f32 v91, v91
  v_exp_f32 v92, v92
  v_exp_f32 v93, v93
  v_exp_f32 v94, v94
  v_exp_f32 v95, v95
  s_waitcnt lgkmcnt(1)
  v_mfma_f32_32x32x16_bf16 v[64:79], v[96:99], v[28:31], v[32:47]
  ds_read_b128 v[96:99], v14 offset:20800
  v_exp_f32 v112, v112
  v_exp_f32 v113, v113
  v_exp_f32 v114, v114
  v_exp_f32 v115, v115
  v_exp_f32 v116, v116
  v_smfmac_f32_32x32x32_bf16 v[48:63], v[104:107], v[88:95], v13
  ds_read_b128 v[104:107], v16 offset:16640
  v_exp_f32 v117, v117
  v_exp_f32 v118, v118
  v_exp_f32 v119, v119
  v_exp_f32 v120, v120
  v_exp_f32 v121, v121
  v_exp_f32 v122, v122
  s_waitcnt lgkmcnt(2)
  v_smfmac_f32_32x32x32_bf16 v[48:63], v[100:103], v[112:119], v13
  ds_read_b128 v[100:103], v15 offset:18720
  v_exp_f32 v123, v123
  v_exp_f32 v124, v124
  v_exp_f32 v125, v125
  v_exp_f32 v126, v126
  v_exp_f32 v127, v127
  s_waitcnt lgkmcnt(1)
  v_mfma_f32_32x32x16_bf16 v[80:95], v[96:99], v[28:31], v[32:47]
  ds_read_b128 v[96:99], v14 offset:22880
  v_exp_f32 v64, v64
  v_exp_f32 v65, v65
  v_exp_f32 v66, v66
  v_exp_f32 v67, v67
  v_exp_f32 v68, v68
  v_smfmac_f32_32x32x32_bf16 v[48:63], v[104:107], v[120:127], v13
  ds_read_b128 v[104:107], v16 offset:18720
  v_exp_f32 v69, v69
  v_exp_f32 v70, v70
  v_exp_f32 v71, v71
  v_exp_f32 v72, v72
  v_exp_f32 v73, v73
  v_exp_f32 v74, v74
  s_waitcnt lgkmcnt(2)
  v_smfmac_f32_32x32x32_bf16 v[48:63], v[100:103], v[64:71], v13
  ds_read_b128 v[100:103], v15 offset:20800
  v_exp_f32 v75, v75
  v_exp_f32 v76, v76
  v_exp_f32 v77, v77
  v_exp_f32 v78, v78
  v_exp_f32 v79, v79
  s_waitcnt lgkmcnt(1)
  v_mfma_f32_32x32x16_bf16 v[112:127], v[96:99], v[28:31], v[32:47]
  ds_read_b128 v[96:99], v14 offset:24960
  v_exp_f32 v80, v80
  v_exp_f32 v81, v81
  v_exp_f32 v82, v82
  v_exp_f32 v83, v83
  v_exp_f32 v84, v84
  v_smfmac_f32_32x32x32_bf16 v[48:63], v[104:107], v[72:79], v13
  ds_read_b128 v[104:107], v16 offset:20800
  buffer_load_dwordx4 v[192:195], v2, s[28:31], s63 offen sc1
  v_exp_f32 v85, v85
  v_exp_f32 v86, v86
  v_exp_f32 v87, v87
  v_exp_f32 v88, v88
  v_exp_f32 v89, v89
  v_exp_f32 v90, v90
  s_waitcnt lgkmcnt(2)
  v_smfmac_f32_32x32x32_bf16 v[48:63], v[100:103], v[80:87], v13
  ds_read_b128 v[100:103], v15 offset:22880
  v_exp_f32 v91, v91
  v_exp_f32 v92, v92
  v_exp_f32 v93, v93
  v_exp_f32 v94, v94
  v_exp_f32 v95, v95
  s_waitcnt lgkmcnt(1)
  v_mfma_f32_32x32x16_bf16 v[64:79], v[96:99], v[28:31], v[32:47]
  ds_read_b128 v[96:99], v14 offset:27040
  v_exp_f32 v112, v112
  v_exp_f32 v113, v113
  v_exp_f32 v114, v114
  v_exp_f32 v115, v115
  v_exp_f32 v116, v116
  v_smfmac_f32_32x32x32_bf16 v[48:63], v[104:107], v[88:95], v13
  ds_read_b128 v[104:107], v16 offset:22880
  v_exp_f32 v117, v117
  v_exp_f32 v118, v118
  v_exp_f32 v119, v119
  v_exp_f32 v120, v120
  v_exp_f32 v121, v121
  v_exp_f32 v122, v122
  s_waitcnt lgkmcnt(2)
  v_smfmac_f32_32x32x32_bf16 v[48:63], v[100:103], v[112:119], v13
  ds_read_b128 v[100:103], v15 offset:24960
  v_exp_f32 v123, v123
  v_exp_f32 v124, v124
  v_exp_f32 v125, v125
  v_exp_f32 v126, v126
  v_exp_f32 v127, v127
  s_waitcnt lgkmcnt(1)
  v_mfma_f32_32x32x16_bf16 v[80:95], v[96:99], v[28:31], v[32:47]
  ds_read_b128 v[96:99], v14 offset:29120
  v_exp_f32 v64, v64
  v_exp_f32 v65, v65
  v_exp_f32 v66, v66
  v_exp_f32 v67, v67
  v_exp_f32 v68, v68
  v_smfmac_f32_32x32x32_bf16 v[48:63], v[104:107], v[120:127], v13
  ds_read_b128 v[104:107], v16 offset:24960
  v_exp_f32 v69, v69
  v_exp_f32 v70, v70
  v_exp_f32 v71, v71
  v_exp_f32 v72, v72
  v_exp_f32 v73, v73
  v_exp_f32 v74, v74
  s_waitcnt lgkmcnt(2)
  v_smfmac_f32_32x32x32_bf16 v[48:63], v[100:103], v[64:71], v13
  ds_read_b128 v[100:103], v15 offset:27040
  v_exp_f32 v75, v75
  v_exp_f32 v76, v76
  v_exp_f32 v77, v77
  v_exp_f32 v78, v78
  v_exp_f32 v79, v79
  s_waitcnt lgkmcnt(1)
  v_mfma_f32_32x32x16_bf16 v[112:127], v[96:99], v[28:31], v[32:47]
  ds_read_b128 v[96:99], v14 offset:31200
  v_exp_f32 v80, v80
  v_exp_f32 v81, v81
  v_exp_f32 v82, v82
  v_exp_f32 v83, v83
  v_exp_f32 v84, v84
  v_smfmac_f32_32x32x32_bf16 v[48:63], v[104:107], v[72:79], v13
  ds_read_b128 v[104:107], v16 offset:27040
  v_exp_f32 v85, v85
  v_exp_f32 v86, v86
  v_exp_f32 v87, v87
  v_exp_f32 v88, v88
  v_exp_f32 v89, v89
  v_exp_f32 v90, v90
  s_waitcnt lgkmcnt(2)
  v_smfmac_f32_32x32x32_bf16 v[48:63], v[100:103], v[80:87], v13
  ds_read_b128 v[100:103], v15 offset:29120
  v_exp_f32 v91, v91
  v_exp_f32 v92, v92
  v_exp_f32 v93, v93
  v_exp_f32 v94, v94
  v_exp_f32 v95, v95
  s_waitcnt lgkmcnt(1)
  v_mfma_f32_32x32x16_bf16 v[64:79], v[96:99], v[28:31], v[32:47]
  ds_read_b128 v[96:99], v14 offset:33280
  v_exp_f32 v112, v112
  v_exp_f32 v113, v113
  v_exp_f32 v114, v114
  v_exp_f32 v115, v115
  v_exp_f32 v116, v116
  v_smfmac_f32_32x32x32_bf16 v[48:63], v[104:107], v[88:95], v13
  ds_read_b128 v[104:107], v16 offset:29120
  s_mov_b32 s61, 0
  s_waitcnt vmcnt(0)
Lpollm:
  v_xor_b32 v192, s49, v192
  v_xor_b32 v193, s49, v193
  v_xor_b32 v194, s49, v194
  v_xor_b32 v195, s49, v195
  v_or3_b32 v192, v192, v193, v194
  v_or_b32 v192, v192, v195
  v_cmp_ne_u32 vcc, 0, v192
  s_add_u32 s61, s61, 1
  s_cmp_gt_u32 s61, 262144
  s_cbranch_vccz Lpollm_ok
  s_cbranch_scc1 Lpollm_ok
  s_sleep 8
  buffer_load_dwordx4 v[192:195], v2, s[28:31], s63 offen sc1
  s_waitcnt vmcnt(0)
  s_branch Lpollm
Lpollm_ok:
  s_lshl_b32 s56, s41, 2
  s_add_u32 s56, s56, s43
  s_lshl_b32 s56, s56, 7
  s_add_u32 s56, s56, 13631488
  buffer_load_dword v22, v24, s[28:31], s56 offen sc1
  v_exp_f32 v117, v117
  v_exp_f32 v118, v118
  v_exp_f32 v119, v119
  v_exp_f32 v120, v120
  v_exp_f32 v121, v121
  v_exp_f32 v122, v122
  s_waitcnt lgkmcnt(2)
  v_smfmac_f32_32x32x32_bf16 v[48:63], v[100:103], v[112:119], v13
  ds_read_b128 v[100:103], v15 offset:31200
  s_add_u32 s92, s51, 32768
  buffer_load_dwordx4 v[192:195], v2, s[28:31], s92 offen offset:0 sc1
  v_exp_f32 v123, v123
  v_exp_f32 v124, v124
  v_exp_f32 v125, v125
  v_exp_f32 v126, v126
  v_exp_f32 v127, v127
  s_waitcnt lgkmcnt(1)
  v_mfma_f32_32x32x16_bf16 v[80:95], v[96:99], v[28:31], v[32:47]
  ds_read_b128 v[96:99], v14 offset:35360
  v_exp_f32 v64, v64
  v_exp_f32 v65, v65
  v_exp_f32 v66, v66
  v_exp_f32 v67, v67
  v_exp_f32 v68, v68
  v_smfmac_f32_32x32x32_bf16 v[48:63], v[104:107], v[120:127], v13
  ds_read_b128 v[104:107], v16 offset:31200
  buffer_load_dwordx4 v[196:199], v2, s[28:31], s92 offen offset:1024 sc1
  v_exp_f32 v69, v69
  v_exp_f32 v70, v70
  v_exp_f32 v71, v71
  v_exp_f32 v72, v72
  v_exp_f32 v73, v73
  v_exp_f32 v74, v74
  s_waitcnt lgkmcnt(2)
  v_smfmac_f32_32x32x32_bf16 v[48:63], v[100:103], v[64:71], v13
  ds_read_b128 v[100:103], v15 offset:33280
  buffer_load_dwordx4 v[200:203], v2, s[28:31], s92 offen offset:2048 sc1
  v_exp_f32 v75, v75
  v_exp_f32 v76, v76
  v_exp_f32 v77, v77
  v_exp_f32 v78, v78
  v_exp_f32 v79, v79
  s_waitcnt lgkmcnt(1)
  v_mfma_f32_32x32x16_bf16 v[112:127], v[96:99], v[28:31], v[32:47]
  ds_read_b128 v[96:99], v14 offset:37440
  v_exp_f32 v80, v80
  v_exp_f32 v81, v81
  v_exp_f32 v82, v82
  v_exp_f32 v83, v83
  v_exp_f32 v84, v84
  v_smfmac_f32_32x32x32_bf16 v[48:63], v[104:107], v[72:79], v13
  ds_read_b128 v[104:107], v16 offset:33280
  buffer_load_dwordx4 v[204:207], v2, s[28:31], s92 offen offset:3072 sc1
  v_exp_f32 v85, v85
  v_exp_f32 v86, v86
  v_exp_f32 v87, v87
  v_exp_f32 v88, v88
  v_exp_f32 v89, v89
  v_exp_f32 v90, v90
  s_waitcnt lgkmcnt(2)
  v_smfmac_f32_32x32x32_bf16 v[48:63], v[100:103], v[80:87], v13
  ds_read_b128 v[100:103], v15 offset:35360
  s_add_u32 s92, s51, 36864
  buffer_load_dwordx4 v[208:211], v2, s[28:31], s92 offen offset:0 sc1
  v_exp_f32 v91, v91
  v_exp_f32 v92, v92
  v_exp_f32 v93, v93
  s_mov_b32 m0, s95
  s_nop 0
  buffer_load_dwordx4 v2, s[28:31], s0 offen offset:0 sc1 lds
  v_exp_f32 v94, v94
  v_exp_f32 v95, v95
  s_waitcnt lgkmcnt(1)
  v_mfma_f32_32x32x16_bf16 v[64:79], v[96:99], v[28:31], v[32:47]
  ds_read_b128 v[96:99], v14 offset:39520
  v_exp_f32 v112, v112
  v_exp_f32 v113, v113
  v_exp_f32 v114, v114
  v_exp_f32 v115, v115
  v_exp_f32 v116, v116
  v_smfmac_f32_32x32x32_bf16 v[48:63], v[104:107], v[88:95], v13
  ds_read_b128 v[104:107], v16 offset:35360
  v_exp_f32 v117, v117
  v_exp_f32 v118, v118
  v_exp_f32 v119, v119
  v_exp_f32 v120, v120
  v_exp_f32 v121, v121
  v_exp_f32 v122, v122
  s_waitcnt lgkmcnt(2)
  v_smfmac_f32_32x32x32_bf16 v[48:63], v[100:103], v[112:119], v13
  ds_read_b128 v[100:103], v15 offset:37440
  buffer_load_dwordx4 v[212:215], v2, s[28:31], s92 offen offset:1024 sc1
  v_exp_f32 v123, v123
  v_exp_f32 v124, v124
  v_exp_f32 v125, v125
  v_exp_f32 v126, v126
  v_exp_f32 v127, v127
  s_waitcnt lgkmcnt(1)
  v_mfma_f32_32x32x16_bf16 v[80:95], v[96:99], v[28:31], v[32:47]
  ds_read_b128 v[96:99], v14 offset:41600
  v_exp_f32 v64, v64
  v_exp_f32 v65, v65
  v_exp_f32 v66, v66
  v_exp_f32 v67, v67
  v_exp_f32 v68, v68
  v_smfmac_f32_32x32x32_bf16 v[48:63], v[104:107], v[120:127], v13
  ds_read_b128 v[104:107], v16 offset:37440
  buffer_load_dwordx4 v[216:219], v2, s[28:31], s92 offen offset:2048 sc1
  v_exp_f32 v69, v69
  v_exp_f32 v70, v70
  v_exp_f32 v71, v71
  v_exp_f32 v72, v72
  v_exp_f32 v73, v73
  v_exp_f32 v74, v74
  s_waitcnt lgkmcnt(2)
  v_smfmac_f32_32x32x32_bf16 v[48:63], v[100:103], v[64:71], v13
  ds_read_b128 v[100:103], v15 offset:39520
  buffer_load_dwordx4 v[220:223], v2, s[28:31], s92 offen offset:3072 sc1
  v_exp_f32 v75, v75
  v_exp_f32 v76, v76
  v_exp_f32 v77, v77
  v_exp_f32 v78, v78
  v_exp_f32 v79, v79
  s_waitcnt lgkmcnt(1)
  v_mfma_f32_32x32x16_bf16 v[112:127], v[96:99], v[28:31], v[32:47]
  ds_read_b128 v[96:99], v14 offset:43680
  v_exp_f32 v80, v80
  v_exp_f32 v81, v81
  v_exp_f32 v82, v82
  v_exp_f32 v83, v83
  v_exp_f32 v84, v84
  v_smfmac_f32_32x32x32_bf16 v[48:63], v[104:107], v[72:79], v13
  ds_read_b128 v[104:107], v16 offset:39520
  s_add_u32 s92, s51, 40960
  buffer_load_dwordx4 v[224:227], v2, s[28:31], s92 offen offset:0 sc1
  v_exp_f32 v85, v85
  v_exp_f32 v86, v86
  v_exp_f32 v87, v87
  v_exp_f32 v88, v88
  v_exp_f32 v89, v89
  v_exp_f32 v90, v90
  s_waitcnt lgkmcnt(2)
  v_smfmac_f32_32x32x32_bf16 v[48:63], v[100:103], v[80:87], v13
  ds_read_b128 v[100:103], v15 offset:41600
  buffer_load_dwordx4 v[228:231], v2, s[28:31], s92 offen offset:1024 sc1
  v_exp_f32 v91, v91
  v_exp_f32 v92, v92
  v_exp_f32 v93, v93
  buffer_load_dwordx4 v2, s[28:31], s0 offen offset:1024 sc1 lds
  v_exp_f32 v94, v94
  v_exp_f32 v95, v95
  s_waitcnt lgkmcnt(1)
  v_mfma_f32_32x32x16_bf16 v[64:79], v[96:99], v[28:31], v[32:47]
  ds_read_b128 v[96:99], v14 offset:45760
  v_exp_f32 v112, v112
  v_exp_f32 v113, v113
  v_exp_f32 v114, v114
  v_exp_f32 v115, v115
  v_exp_f32 v116, v116
  v_smfmac_f32_32x32x32_bf16 v[48:63], v[104:107], v[88:95], v13
  ds_read_b128 v[104:107], v16 offset:41600
  v_exp_f32 v117, v117
  v_exp_f32 v118, v118
  v_exp_f32 v119, v119
  v_exp_f32 v120, v120
  v_exp_f32 v121, v121
  v_exp_f32 v122, v122
  s_waitcnt lgkmcnt(2)
  v_smfmac_f32_32x32x32_bf16 v[48:63], v[100:103], v[112:119], v13
  ds_read_b128 v[100:103], v15 offset:43680
  buffer_load_dwordx4 v[232:235], v2, s[28:31], s92 offen offset:2048 sc1
  v_exp_f32 v123, v123
  v_exp_f32 v124, v124
  v_exp_f32 v125, v125
  v_exp_f32 v126, v126
  v_exp_f32 v127, v127
  s_waitcnt lgkmcnt(1)
  v_mfma_f32_32x32x16_bf16 v[80:95], v[96:99], v[28:31], v[32:47]
  ds_read_b128 v[96:99], v14 offset:47840
  v_exp_f32 v64, v64
  v_exp_f32 v65, v65
  v_exp_f32 v66, v66
  v_exp_f32 v67, v67
  v_exp_f32 v68, v68
  v_smfmac_f32_32x32x32_bf16 v[48:63], v[104:107], v[120:127], v13
  ds_read_b128 v[104:107], v16 offset:43680
  buffer_load_dwordx4 v[236:239], v2, s[28:31], s92 offen offset:3072 sc1
  v_exp_f32 v69, v69
  v_exp_f32 v70, v70
  v_exp_f32 v71, v71
  v_exp_f32 v72, v72
  v_exp_f32 v73, v73
  v_exp_f32 v74, v74
  s_waitcnt lgkmcnt(2)
  v_smfmac_f32_32x32x32_bf16 v[48:63], v[100:103], v[64:71], v13
  ds_read_b128 v[100:103], v15 offset:45760
  s_add_u32 s92, s51, 45056
  buffer_load_dwordx4 v[240:243], v2, s[28:31], s92 offen offset:0 sc1
  v_exp_f32 v75, v75
  v_exp_f32 v76, v76
  v_exp_f32 v77, v77
  v_exp_f32 v78, v78
  v_exp_f32 v79, v79
  s_waitcnt lgkmcnt(1)
  v_mfma_f32_32x32x16_bf16 v[112:127], v[96:99], v[28:31], v[32:47]
  ds_read_b128 v[96:99], v14 offset:49920
  v_exp_f32 v80, v80
  v_exp_f32 v81, v81
  v_exp_f32 v82, v82
  v_exp_f32 v83, v83
  v_exp_f32 v84, v84
  v_smfmac_f32_32x32x32_bf16 v[48:63], v[104:107], v[72:79], v13
  ds_read_b128 v[104:107], v16 offset:45760
  buffer_load_dwordx4 v[244:247], v2, s[28:31], s92 offen offset:1024 sc1
  v_exp_f32 v85, v85
  v_exp_f32 v86, v86
  v_exp_f32 v87, v87
  v_exp_f32 v88, v88
  v_exp_f32 v89, v89
  v_exp_f32 v90, v90
  s_waitcnt lgkmcnt(2)
  v_smfmac_f32_32x32x32_bf16 v[48:63], v[100:103], v[80:87], v13
  ds_read_b128 v[100:103], v15 offset:47840
  buffer_load_dwordx4 v[248:251], v2, s[28:31], s92 offen offset:2048 sc1
  v_exp_f32 v91, v91
  v_exp_f32 v92, v92
  v_exp_f32 v93, v93
  buffer_load_dwordx4 v2, s[28:31], s0 offen offset:2048 sc1 lds
  v_exp_f32 v94, v94
  v_exp_f32 v95, v95
  s_waitcnt lgkmcnt(1)
  v_mfma_f32_32x32x16_bf16 v[64:79], v[96:99], v[28:31], v[32:47]
  ds_read_b128 v[96:99], v14 offset:52000
  v_exp_f32 v112, v112
  v_exp_f32 v113, v113
  v_exp_f32 v114, v114
  v_exp_f32 v115, v115
  v_exp_f32 v116, v116
  v_smfmac_f32_32x32x32_bf16 v[48:63], v[104:107], v[88:95], v13
  ds_read_b128 v[104:107], v16 offset:47840
  v_exp_f32 v117, v117
  v_exp_f32 v118, v118
  v_exp_f32 v119, v119
  v_exp_f32 v120, v120
  v_exp_f32 v121, v121
  v_exp_f32 v122, v122
  s_waitcnt lgkmcnt(2)
  v_smfmac_f32_32x32x32_bf16 v[48:63], v[100:103], v[112:119], v13
  ds_read_b128 v[100:103], v15 offset:49920
  buffer_load_dwordx4 v[252:255], v2, s[28:31], s92 offen offset:3072 sc1
  v_exp_f32 v123, v123
  v_exp_f32 v124, v124
  v_exp_f32 v125, v125
  v_exp_f32 v126, v126
  v_exp_f32 v127, v127
  v_add_u32 v14, 49920, v14
  v_add_u32 v15, 49920, v15
  v_add_u32 v16, 49920, v16
  s_waitcnt lgkmcnt(1)
  v_mfma_f32_32x32x16_bf16 v[80:95], v[96:99], v[28:31], v[32:47]
  ds_read_b128 v[96:99], v14 offset:4160
  v_exp_f32 v64, v64
  v_exp_f32 v65, v65
  v_exp_f32 v66, v66
  v_exp_f32 v67, v67
  v_exp_f32 v68, v68
  v_smfmac_f32_32x32x32_bf16 v[48:63], v[104:107], v[120:127], v13
  ds_read_b128 v[104:107], v16 offset:0
  s_add_u32 s92, s51, 0
  buffer_load_dwordx4 v[128:131], v2, s[28:31], s92 offen offset:0 sc1
  v_exp_f32 v69, v69
  v_exp_f32 v70, v70
  v_exp_f32 v71, v71
  v_exp_f32 v72, v72
  v_exp_f32 v73, v73
  v_exp_f32 v74, v74
  s_waitcnt lgkmcnt(2)
  v_smfmac_f32_32x32x32_bf16 v[48:63], v[100:103], v[64:71], v13
  ds_read_b128 v[100:103], v15 offset:2080
  buffer_load_dwordx4 v[132:135], v2, s[28:31], s92 offen offset:1024 sc1
  v_exp_f32 v75, v75
  v_exp_f32 v76, v76
  v_exp_f32 v77, v77
  v_exp_f32 v78, v78
  v_exp_f32 v79, v79
  s_waitcnt lgkmcnt(1)
  v_mfma_f32_32x32x16_bf16 v[112:127], v[96:99], v[28:31], v[32:47]
  ds_read_b128 v[96:99], v14 offset:6240
  v_exp_f32 v80, v80
  v_exp_f32 v81, v81
  v_exp_f32 v82, v82
  v_exp_f32 v83, v83
  v_exp_f32 v84, v84
  v_smfmac_f32_32x32x32_bf16 v[48:63], v[104:107], v[72:79], v13
  ds_read_b128 v[104:107], v16 offset:2080
  buffer_load_dwordx4 v[136:139], v2, s[28:31], s92 offen offset:2048 sc1
  v_exp_f32 v85, v85
  v_exp_f32 v86, v86
  v_exp_f32 v87, v87
  v_exp_f32 v88, v88
  v_exp_f32 v89, v89
  v_exp_f32 v90, v90
  s_waitcnt lgkmcnt(2)
  v_smfmac_f32_32x32x32_bf16 v[48:63], v[100:103], v[80:87], v13
  ds_read_b128 v[100:103], v15 offset:4160
  buffer_load_dwordx4 v[140:143], v2, s[28:31], s92 offen offset:3072 sc1
  v_exp_f32 v91, v91
  v_exp_f32 v92, v92
  v_exp_f32 v93, v93
  s_cmp_eq_u32 s48, 3
  s_cbranch_scc1 Lnod
  buffer_load_dwordx4 v2, s[28:31], s0 offen offset:3072 sc1 lds
Lnod:
  s_add_u32 s60, s50, 15360
  buffer_load_dwordx4 v[108:111], v2, s[28:31], s60 offen sc1
  v_exp_f32 v94, v94
  v_exp_f32 v95, v95
  s_setprio 1
  s_waitcnt lgkmcnt(1)
  v_mfma_f32_32x32x16_bf16 v[64:79], v[96:99], v[28:31], v[32:47]
  ds_read_b128 v[96:99], v14 offset:8320
  v_exp_f32 v112, v112
  v_exp_f32 v113, v113
  v_exp_f32 v114, v114
  v_exp_f32 v115, v115
  v_exp_f32 v116, v116
  v_smfmac_f32_32x32x32_bf16 v[48:63], v[104:107], v[88:95], v13
  ds_read_b128 v[104:107], v16 offset:4160
  v_exp_f32 v117, v117
  v_exp_f32 v118, v118
  v_exp_f32 v119, v119
  v_exp_f32 v120, v120
  v_exp_f32 v121, v121
  v_exp_f32 v122, v122
  s_waitcnt lgkmcnt(2)
  v_smfmac_f32_32x32x32_bf16 v[48:63], v[100:103], v[112:119], v13
  ds_read_b128 v[100:103], v15 offset:6240
  s_add_u32 s92, s51, 4096
  buffer_load_dwordx4 v[144:147], v2, s[28:31], s92 offen offset:0 sc1
  v_exp_f32 v123, v123
  v_exp_f32 v124, v124
  v_exp_f32 v125, v125
  v_exp_f32 v126, v126
  v_exp_f32 v127, v127
  s_waitcnt lgkmcnt(1)
  v_mfma_f32_32x32x16_bf16 v[80:95], v[96:99], v[28:31], v[32:47]
  ds_read_b128 v[96:99], v14 offset:10400
  v_exp_f32 v64, v64
  v_exp_f32 v65, v65
  v_exp_f32 v66, v66
  v_exp_f32 v67, v67
  v_exp_f32 v68, v68
  v_smfmac_f32_32x32x32_bf16 v[48:63], v[104:107], v[120:127], v13
  ds_read_b128 v[104:107], v16 offset:6240
  buffer_load_dwordx4 v[148:151], v2, s[28:31], s92 offen offset:1024 sc1
  v_exp_f32 v69, v69
  v_exp_f32 v70, v70
  v_exp_f32 v71, v71
  v_exp_f32 v72, v72
  v_exp_f32 v73, v73
  v_exp_f32 v74, v74
  s_waitcnt lgkmcnt(2)
  v_smfmac_f32_32x32x32_bf16 v[48:63], v[100:103], v[64:71], v13
  ds_read_b128 v[100:103], v15 offset:8320
  buffer_load_dwordx4 v[152:155], v2, s[28:31], s92 offen offset:2048 sc1
  v_exp_f32 v75, v75
  v_exp_f32 v76, v76
  v_exp_f32 v77, v77
  v_exp_f32 v78, v78
  v_exp_f32 v79, v79
  s_waitcnt lgkmcnt(1)
  v_mfma_f32_32x32x16_bf16 v[112:127], v[96:99], v[28:31], v[32:47]
  ds_read_b128 v[96:99], v14 offset:12480
  v_exp_f32 v80, v80
  v_exp_f32 v81, v81
  v_exp_f32 v82, v82
  v_exp_f32 v83, v83
  v_exp_f32 v84, v84
  v_smfmac_f32_32x32x32_bf16 v[48:63], v[104:107], v[72:79], v13
  ds_read_b128 v[104:107], v16 offset:8320
  buffer_load_dwordx4 v[156:159], v2, s[28:31], s92 offen offset:3072 sc1
  v_exp_f32 v85, v85
  v_exp_f32 v86, v86
  v_exp_f32 v87, v87
  v_exp_f32 v88, v88
  v_exp_f32 v89, v89
  v_exp_f32 v90, v90
  s_waitcnt lgkmcnt(2)
  v_smfmac_f32_32x32x32_bf16 v[48:63], v[100:103], v[80:87], v13
  ds_read_b128 v[100:103], v15 offset:10400
  s_add_u32 s92, s51, 8192
  buffer_load_dwordx4 v[160:163], v2, s[28:31], s92 offen offset:0 sc1
  v_exp_f32 v91, v91
  v_exp_f32 v92, v92
  v_exp_f32 v93, v93
  v_exp_f32 v94, v94
  v_exp_f32 v95, v95
  s_waitcnt lgkmcnt(1)
  v_mfma_f32_32x32x16_bf16 v[64:79], v[96:99], v[28:31], v[32:47]
  ds_read_b128 v[96:99], v14 offset:14560
  v_exp_f32 v112, v112
  v_exp_f32 v113, v113
  v_exp_f32 v114, v114
  v_exp_f32 v115, v115
  v_exp_f32 v116, v116
  v_smfmac_f32_32x32x32_bf16 v[48:63], v[104:107], v[88:95], v13
  ds_read_b128 v[104:107], v16 offset:10400
  v_exp_f32 v117, v117
  v_exp_f32 v118, v118
  v_exp_f32 v119, v119
  v_exp_f32 v120, v120
  v_exp_f32 v121, v121
  v_exp_f32 v122, v122
  s_waitcnt lgkmcnt(2)
  v_smfmac_f32_32x32x32_bf16 v[48:63], v[100:103], v[112:119], v13
  ds_read_b128 v[100:103], v15 offset:12480
  buffer_load_dwordx4 v[164:167], v2, s[28:31], s92 offen offset:1024 sc1
  v_exp_f32 v123, v123
  v_exp_f32 v124, v124
  v_exp_f32 v125, v125
  v_exp_f32 v126, v126
  v_exp_f32 v127, v127
  s_waitcnt lgkmcnt(1)
  v_mfma_f32_32x32x16_bf16 v[80:95], v[96:99], v[28:31], v[32:47]
  ds_read_b128 v[96:99], v14 offset:16640
  v_exp_f32 v64, v64
  v_exp_f32 v65, v65
  v_exp_f32 v66, v66
  v_exp_f32 v67, v67
  v_exp_f32 v68, v68
  v_smfmac_f32_32x32x32_bf16 v[48:63], v[104:107], v[120:127], v13
  ds_read_b128 v[104:107], v16 offset:12480
  buffer_load_dwordx4 v[168:171], v2, s[28:31], s92 offen offset:2048 sc1
  v_exp_f32 v69, v69
  v_exp_f32 v70, v70
  v_exp_f32 v71, v71
  v_exp_f32 v72, v72
  v_exp_f32 v73, v73
  v_exp_f32 v74, v74
  s_waitcnt lgkmcnt(2)
  v_smfmac_f32_32x32x32_bf16 v[48:63], v[100:103], v[64:71], v13
  ds_read_b128 v[100:103], v15 offset:14560
  buffer_load_dwordx4 v[172:175], v2, s[28:31], s92 offen offset:3072 sc1
  v_exp_f32 v75, v75
  v_exp_f32 v76, v76
  v_exp_f32 v77, v77
  v_exp_f32 v78, v78
  v_exp_f32 v79, v79
  s_waitcnt lgkmcnt(1)
  v_mfma_f32_32x32x16_bf16 v[112:127], v[96:99], v[28:31], v[32:47]
  ds_read_b128 v[96:99], v14 offset:18720
  v_exp_f32 v80, v80
  v_exp_f32 v81, v81
  v_exp_f32 v82, v82
  v_exp_f32 v83, v83
  v_exp_f32 v84, v84
  v_smfmac_f32_32x32x32_bf16 v[48:63], v[104:107], v[72:79], v13
  ds_read_b128 v[104:107], v16 offset:14560
  s_add_u32 s92, s51, 12288
  buffer_load_dwordx4 v[176:179], v2, s[28:31], s92 offen offset:0 sc1
  v_exp_f32 v85, v85
  v_exp_f32 v86, v86
  v_exp_f32 v87, v87
  v_exp_f32 v88, v88
  v_exp_f32 v89, v89
  v_exp_f32 v90, v90
  s_waitcnt lgkmcnt(2)
  v_smfmac_f32_32x32x32_bf16 v[48:63], v[100:103], v[80:87], v13
  ds_read_b128 v[100:103], v15 offset:16640
  buffer_load_dwordx4 v[180:183], v2, s[28:31], s92 offen offset:1024 sc1
  v_exp_f32 v91, v91
  v_exp_f32 v92, v92
  v_exp_f32 v93, v93
  v_exp_f32 v94, v94
  v_exp_f32 v95, v95
  s_waitcnt lgkmcnt(1)
  v_mfma_f32_32x32x16_bf16 v[64:79], v[96:99], v[28:31], v[32:47]
  ds_read_b128 v[96:99], v14 offset:20800
  v_exp_f32 v112, v112
  v_exp_f32 v113, v113
  v_exp_f32 v114, v114
  v_exp_f32 v115, v115
  v_exp_f32 v116, v116
  v_smfmac_f32_32x32x32_bf16 v[48:63], v[104:107], v[88:95], v13
  ds_read_b128 v[104:107], v16 offset:16640
  v_exp_f32 v117, v117
  v_exp_f32 v118, v118
  v_exp_f32 v119, v119
  v_exp_f32 v120, v120
  v_exp_f32 v121, v121
  v_exp_f32 v122, v122
  s_waitcnt lgkmcnt(2)
  v_smfmac_f32_32x32x32_bf16 v[48:63], v[100:103], v[112:119], v13
  ds_read_b128 v[100:103], v15 offset:18720
  buffer_load_dwordx4 v[184:187], v2, s[28:31], s92 offen offset:2048 sc1
  v_exp_f32 v123, v123
  v_exp_f32 v124, v124
  v_exp_f32 v125, v125
  v_exp_f32 v126, v126
  v_exp_f32 v127, v127
  s_waitcnt lgkmcnt(1)
  v_mfma_f32_32x32x16_bf16 v[80:95], v[96:99], v[28:31], v[32:47]
  ds_read_b128 v[96:99], v14 offset:22880
  v_exp_f32 v64, v64
  v_exp_f32 v65, v65
  v_exp_f32 v66, v66
  v_exp_f32 v67, v67
  v_exp_f32 v68, v68
  v_smfmac_f32_32x32x32_bf16 v[48:63], v[104:107], v[120:127], v13
  ds_read_b128 v[104:107], v16 offset:18720
  buffer_load_dwordx4 v[188:191], v2, s[28:31], s92 offen offset:3072 sc1
  v_exp_f32 v69, v69
  v_exp_f32 v70, v70
  v_exp_f32 v71, v71
  v_exp_f32 v72, v72
  v_exp_f32 v73, v73
  v_exp_f32 v74, v74
  s_waitcnt lgkmcnt(2)
  v_smfmac_f32_32x32x32_bf16 v[48:63], v[100:103], v[64:71], v13
  ds_read_b128 v[100:103], v15 offset:20800
  v_exp_f32 v75, v75
  v_exp_f32 v76, v76
  v_exp_f32 v77, v77
  v_exp_f32 v78, v78
  v_exp_f32 v79, v79
  s_waitcnt lgkmcnt(1)
  v_mfma_f32_32x32x16_bf16 v[112:127], v[96:99], v[28:31], v[32:47]
  ds_read_b128 v[96:99], v14 offset:24960
  v_exp_f32 v80, v80
  v_exp_f32 v81, v81
  v_exp_f32 v82, v82
  v_exp_f32 v83, v83
  v_exp_f32 v84, v84
  v_smfmac_f32_32x32x32_bf16 v[48:63], v[104:107], v[72:79], v13
  ds_read_b128 v[104:107], v16 offset:20800
  v_exp_f32 v85, v85
  v_exp_f32 v86, v86
  v_exp_f32 v87, v87
  v_exp_f32 v88, v88
  v_exp_f32 v89, v89
  v_exp_f32 v90, v90
  s_waitcnt lgkmcnt(2)
  v_smfmac_f32_32x32x32_bf16 v[48:63], v[100:103], v[80:87], v13
  ds_read_b128 v[100:103], v15 offset:22880
  v_exp_f32 v91, v91
  v_exp_f32 v92, v92
  v_exp_f32 v93, v93
  v_exp_f32 v94, v94
  v_exp_f32 v95, v95
  s_waitcnt lgkmcnt(1)
  v_mfma_f32_32x32x16_bf16 v[64:79], v[96:99], v[28:31], v[32:47]
  ds_read_b128 v[96:99], v14 offset:27040
  v_exp_f32 v112, v112
  v_exp_f32 v113, v113
  v_exp_f32 v114, v114
  v_exp_f32 v115, v115
  v_exp_f32 v116, v116
  v_smfmac_f32_32x32x32_bf16 v[48:63], v[104:107], v[88:95], v13
  ds_read_b128 v[104:107], v16 offset:22880
  v_exp_f32 v117, v117
  v_exp_f32 v118, v118
  v_exp_f32 v119, v119
  v_exp_f32 v120, v120
  v_exp_f32 v121, v121
  v_exp_f32 v122, v122
  s_waitcnt lgkmcnt(2)
  v_smfmac_f32_32x32x32_bf16 v[48:63], v[100:103], v[112:119], v13
  ds_read_b128 v[100:103], v15 offset:24960
  v_exp_f32 v123, v123
  v_exp_f32 v124, v124
  v_exp_f32 v125, v125
  v_exp_f32 v126, v126
  v_exp_f32 v127, v127
  s_setprio 0
  s_waitcnt lgkmcnt(1)
  v_mfma_f32_32x32x16_bf16 v[80:95], v[96:99], v[28:31], v[32:47]
  ds_read_b128 v[96:99], v14 offset:29120
  v_exp_f32 v64, v64
  v_exp_f32 v65, v65
  v_exp_f32 v66, v66
  v_exp_f32 v67, v67
  v_exp_f32 v68, v68
  v_smfmac_f32_32x32x32_bf16 v[48:63], v[104:107], v[120:127], v13
  ds_read_b128 v[104:107], v16 offset:24960
  v_exp_f32 v69, v69
  v_exp_f32 v70, v70
  v_exp_f32 v71, v71
  v_exp_f32 v72, v72
  v_exp_f32 v73, v73
  v_exp_f32 v74, v74
  s_waitcnt lgkmcnt(2)
  v_smfmac_f32_32x32x32_bf16 v[48:63], v[100:103], v[64:71], v13
  ds_read_b128 v[100:103], v15 offset:27040
  v_exp_f32 v75, v75
  v_exp_f32 v76, v76
  v_exp_f32 v77, v77
  v_exp_f32 v78, v78
  v_exp_f32 v79, v79
  s_waitcnt lgkmcnt(1)
  v_mfma_f32_32x32x16_bf16 v[112:127], v[96:99], v[28:31], v[32:47]
  ds_read_b128 v[96:99], v14 offset:31200
  v_exp_f32 v80, v80
  v_exp_f32 v81, v81
  v_exp_f32 v82, v82
  v_exp_f32 v83, v83
  v_exp_f32 v84, v84
  v_smfmac_f32_32x32x32_bf16 v[48:63], v[104:107], v[72:79], v13
  ds_read_b128 v[104:107], v16 offset:27040
  v_exp_f32 v85, v85
  v_exp_f32 v86, v86
  v_exp_f32 v87, v87
  v_exp_f32 v88, v88
  v_exp_f32 v89, v89
  v_exp_f32 v90, v90
  s_waitcnt lgkmcnt(2)
  v_smfmac_f32_32x32x32_bf16 v[48:63], v[100:103], v[80:87], v13
  ds_read_b128 v[100:103], v15 offset:29120
  v_exp_f32 v91, v91
  v_exp_f32 v92, v92
  v_exp_f32 v93, v93
  v_exp_f32 v94, v94
  v_exp_f32 v95, v95
  s_waitcnt lgkmcnt(1)
  v_mfma_f32_32x32x16_bf16 v[64:79], v[96:99], v[28:31], v[32:47]
  ds_read_b128 v[96:99], v14 offset:33280
  v_exp_f32 v112, v112
  v_exp_f32 v113, v113
  v_exp_f32 v114, v114
  v_exp_f32 v115, v115
  v_exp_f32 v116, v116
  v_smfmac_f32_32x32x32_bf16 v[48:63], v[104:107], v[88:95], v13
  ds_read_b128 v[104:107], v16 offset:29120
  v_exp_f32 v117, v117
  v_exp_f32 v118, v118
  v_exp_f32 v119, v119
  v_exp_f32 v120, v120
  v_exp_f32 v121, v121
  v_exp_f32 v122, v122
  s_waitcnt lgkmcnt(2)
  v_smfmac_f32_32x32x32_bf16 v[48:63], v[100:103], v[112:119], v13
  ds_read_b128 v[100:103], v15 offset:31200
  v_exp_f32 v123, v123
  v_exp_f32 v124, v124
  v_exp_f32 v125, v125
  v_exp_f32 v126, v126
  v_exp_f32 v127, v127
  s_waitcnt lgkmcnt(1)
  v_mfma_f32_32x32x16_bf16 v[80:95], v[96:99], v[28:31], v[32:47]
  ds_read_b128 v[96:99], v14 offset:35360
  v_exp_f32 v64, v64
  v_exp_f32 v65, v65
  v_exp_f32 v66, v66
  v_exp_f32 v67, v67
  v_exp_f32 v68, v68
  v_smfmac_f32_32x32x32_bf16 v[48:63], v[104:107], v[120:127], v13
  ds_read_b128 v[104:107], v16 offset:31200
  v_exp_f32 v69, v69
  v_exp_f32 v70, v70
  v_exp_f32 v71, v71
  v_exp_f32 v72, v72
  v_exp_f32 v73, v73
  v_exp_f32 v74, v74
  s_waitcnt lgkmcnt(2)
  v_smfmac_f32_32x32x32_bf16 v[48:63], v[100:103], v[64:71], v13
  ds_read_b128 v[100:103], v15 offset:33280
  v_exp_f32 v75, v75
  v_exp_f32 v76, v76
  v_exp_f32 v77, v77
  v_exp_f32 v78, v78
  v_exp_f32 v79, v79
  s_waitcnt lgkmcnt(0)
  s_nop 0
  v_smfmac_f32_32x32x32_bf16 v[48:63], v[104:107], v[72:79], v13
Lfinish:
  s_setprio 3
  s_mov_b32 s59, 0x53800000
  s_mov_b32 s61, 0
  s_nop 6
  s_cmp_lg_u32 s54, 0
  s_cbranch_scc1 Lfin
  v_pk_mul_f32 v[96:97], v[48:49], 0
  v_pk_fma_f32 v[96:97], v[50:51], 0, v[96:97]
  v_pk_fma_f32 v[96:97], v[52:53], 0, v[96:97]
  v_pk_fma_f32 v[96:97], v[54:55], 0, v[96:97]
  v_add_f32 v96, v96, v56
  v_add_f32 v96, v96, v97
  v_cmp_ngt_f32 vcc, s59, v96
  s_nop 1
  s_cbranch_vccnz Lfallback
Lfin:
  v_rcp_f32 v9, v56
  s_nop 0
  v_mul_f32 v48, v48, v9
  v_mul_f32 v49, v49, v9
  v_mul_f32 v50, v50, v9
  v_mul_f32 v51, v51, v9
  v_mul_f32 v52, v52, v9
  v_mul_f32 v53, v53, v9
  v_mul_f32 v54, v54, v9
  v_mul_f32 v55, v55, v9
  v_cvt_pk_bf16_f32 v96, v48, v49
  v_cvt_pk_bf16_f32 v97, v50, v51
  v_cvt_pk_bf16_f32 v98, v52, v53
  v_cvt_pk_bf16_f32 v99, v54, v55
  v_min_u32 v96, -2, v96
  v_min_u32 v97, -2, v97
  v_min_u32 v98, -2, v98
  v_min_u32 v99, -2, v99
  buffer_store_dwordx4 v[96:99], v2, s[28:31], s14 offen sc1
  s_setprio 0
  s_mov_b32 s53, 0
  s_mov_b32 s55, 0
  s_waitcnt vmcnt(1)
  s_barrier
  v_sub_f32 v23, 1.0, v22
  v_cvt_pk_bf16_f32 v23, v23, v23
  v_lshlrev_b32 v23, 16, v23
  ds_read_b128 v[64:67], v12 offset:0
  ds_read_b128 v[68:71], v12 offset:1024
  ds_read_b128 v[72:75], v12 offset:2048
  ds_read_b128 v[76:79], v12 offset:3072
  ds_read_b128 v[80:83], v12 offset:4096
  ds_read_b128 v[84:87], v12 offset:5120
  ds_read_b128 v[88:91], v12 offset:6144
  ds_read_b128 v[92:95], v12 offset:7168
  v_mfma_f32_32x32x16_bf16 v[112:127], v[252:255], v[108:111], 0
  s_waitcnt lgkmcnt(7)
  v_mfma_f32_32x32x16_bf16 v[112:127], v[192:195], v[64:67], v[112:127]
  ds_read_b128 v[64:67], v12 offset:8192
  s_waitcnt lgkmcnt(7)
  v_mfma_f32_32x32x16_bf16 v[112:127], v[196:199], v[68:71], v[112:127]
  ds_read_b128 v[68:71], v12 offset:9216
  s_waitcnt lgkmcnt(7)
  v_mfma_f32_32x32x16_bf16 v[112:127], v[200:203], v[72:75], v[112:127]
  ds_read_b128 v[72:75], v12 offset:10240
  s_waitcnt lgkmcnt(7)
  v_mfma_f32_32x32x16_bf16 v[112:127], v[204:207], v[76:79], v[112:127]
  ds_read_b128 v[76:79], v12 offset:11264
  s_waitcnt lgkmcnt(7)
  v_mfma_f32_32x32x16_bf16 v[112:127], v[208:211], v[80:83], v[112:127]
  ds_read_b128 v[80:83], v12 offset:12288
  s_waitcnt lgkmcnt(7)
  v_mfma_f32_32x32x16_bf16 v[112:127], v[212:215], v[84:87], v[112:127]
  ds_read_b128 v[84:87], v12 offset:13312
  s_waitcnt lgkmcnt(7)
  v_mfma_f32_32x32x16_bf16 v[112:127], v[216:219], v[88:91], v[112:127]
  ds_read_b128 v[88:91], v12 offset:14336
  s_waitcnt lgkmcnt(7)
  v_mfma_f32_32x32x16_bf16 v[112:127], v[220:223], v[92:95], v[112:127]
  buffer_load_dwordx4 v[32:35], v2, s[28:31], s62 offen offset:0 sc1
  buffer_load_dwordx4 v[36:39], v2, s[28:31], s62 offen offset:1024 sc1
  buffer_load_dwordx4 v[40:43], v2, s[28:31], s62 offen offset:2048 sc1
  buffer_load_dwordx4 v[44:47], v2, s[28:31], s62 offen offset:3072 sc1
  s_waitcnt lgkmcnt(6)
  v_mfma_f32_32x32x16_bf16 v[112:127], v[224:227], v[64:67], v[112:127]
  s_waitcnt lgkmcnt(5)
  v_mfma_f32_32x32x16_bf16 v[112:127], v[228:231], v[68:71], v[112:127]
  s_waitcnt lgkmcnt(4)
  v_mfma_f32_32x32x16_bf16 v[112:127], v[232:235], v[72:75], v[112:127]
  s_waitcnt lgkmcnt(3)
  v_mfma_f32_32x32x16_bf16 v[112:127], v[236:239], v[76:79], v[112:127]
  s_waitcnt lgkmcnt(2)
  v_mfma_f32_32x32x16_bf16 v[112:127], v[240:243], v[80:83], v[112:127]
  s_waitcnt lgkmcnt(1)
  v_mfma_f32_32x32x16_bf16 v[112:127], v[244:247], v[84:87], v[112:127]
  s_waitcnt lgkmcnt(0)
  v_mfma_f32_32x32x16_bf16 v[112:127], v[248:251], v[88:91], v[112:127]
Lt:
  s_cmp_lg_u32 s53, 0
  s_cbranch_scc1 Lt_own
  s_waitcnt vmcnt(0)
  v_max3_u32 v9, v32, v33, v34
  v_max3_u32 v9, v9, v35, v36
  v_max3_u32 v9, v9, v37, v38
  v_max3_u32 v9, v9, v39, v40
  v_max3_u32 v9, v9, v41, v42
  v_max3_u32 v9, v9, v43, v44
  v_max3_u32 v9, v9, v45, v46
  v_max_u32 v9, v9, v47
  v_cmp_eq_u32 vcc, -1, v9
  s_cmp_gt_u32 s61, 262144
  s_cbranch_scc1 Lt_ok
  s_cbranch_vccz Lt_ok
  s_sleep 10
  buffer_load_dwordx4 v[32:35], v2, s[28:31], s62 offen offset:0 sc1
  buffer_load_dwordx4 v[36:39], v2, s[28:31], s62 offen offset:1024 sc1
  buffer_load_dwordx4 v[40:43], v2, s[28:31], s62 offen offset:2048 sc1
  buffer_load_dwordx4 v[44:47], v2, s[28:31], s62 offen offset:3072 sc1
  s_branch Lt_own
Lt_ok:
  ds_write_b128 v26, v[32:35] offset:0
  ds_write_b128 v26, v[36:39] offset:1024
  ds_write_b128 v26, v[40:43] offset:2048
  ds_write_b128 v26, v[44:47] offset:3072
  ds_write_b32 v4, v13
  s_mov_b32 s53, 16
Lt_own:
  ds_read_b32 v9, v6
  s_add_u32 s61, s61, 1
  s_waitcnt lgkmcnt(0)
  v_cmp_ne_u32 vcc, 0, v9
  s_nop 1
  s_and_b32 s56, vcc_lo, 15
  s_andn2_b32 s56, s56, s55
  s_or_b32 s55, s55, s56
  s_bitcmp1_b32 s56, 0
  s_cbranch_scc0 Lt_g0
  ds_read_b128 v[64:67], v18 offset:0
  ds_read_b128 v[68:71], v18 offset:1024
  ds_read_b128 v[72:75], v18 offset:2048
  ds_read_b128 v[76:79], v18 offset:3072
  s_waitcnt lgkmcnt(3)
  v_mfma_f32_32x32x16_bf16 v[48:63], v[128:131], v[64:67], 0
  s_waitcnt lgkmcnt(2)
  v_mfma_f32_32x32x16_bf16 v[48:63], v[132:135], v[68:71], v[48:63]
  s_waitcnt lgkmcnt(1)
  v_mfma_f32_32x32x16_bf16 v[48:63], v[136:139], v[72:75], v[48:63]
  s_waitcnt lgkmcnt(0)
  v_mfma_f32_32x32x16_bf16 v[48:63], v[140:143], v[76:79], v[48:63]
Lt_g0:
  s_bitcmp1_b32 s56, 1
  s_cbranch_scc0 Lt_g1
  ds_read_b128 v[80:83], v18 offset:4096
  ds_read_b128 v[84:87], v18 offset:5120
  ds_read_b128 v[88:91], v18 offset:6144
  ds_read_b128 v[92:95], v18 offset:7168
  s_waitcnt lgkmcnt(3)
  v_mfma_f32_32x32x16_bf16 v[192:207], v[144:147], v[80:83], 0
  s_waitcnt lgkmcnt(2)
  v_mfma_f32_32x32x16_bf16 v[192:207], v[148:151], v[84:87], v[192:207]
  s_waitcnt lgkmcnt(1)
  v_mfma_f32_32x32x16_bf16 v[192:207], v[152:155], v[88:91], v[192:207]
  s_waitcnt lgkmcnt(0)
  v_mfma_f32_32x32x16_bf16 v[192:207], v[156:159], v[92:95], v[192:207]
Lt_g1:
  s_bitcmp1_b32 s56, 2
  s_cbranch_scc0 Lt_g2
  ds_read_b128 v[64:67], v18 offset:8192
  ds_read_b128 v[68:71], v18 offset:9216
  ds_read_b128 v[72:75], v18 offset:10240
  ds_read_b128 v[76:79], v18 offset:11264
  s_waitcnt lgkmcnt(3)
  v_mfma_f32_32x32x16_bf16 v[208:223], v[160:163], v[64:67], 0
  s_waitcnt lgkmcnt(2)
  v_mfma_f32_32x32x16_bf16 v[208:223], v[164:167], v[68:71], v[208:223]
  s_waitcnt lgkmcnt(1)
  v_mfma_f32_32x32x16_bf16 v[208:223], v[168:171], v[72:75], v[208:223]
  s_waitcnt lgkmcnt(0)
  v_mfma_f32_32x32x16_bf16 v[208:223], v[172:175], v[76:79], v[208:223]
Lt_g2:
  s_bitcmp1_b32 s56, 3
  s_cbranch_scc0 Lt_g3
  ds_read_b128 v[80:83], v18 offset:12288
  ds_read_b128 v[84:87], v18 offset:13312
  ds_read_b128 v[88:91], v18 offset:14336
  ds_read_b128 v[92:95], v18 offset:15360
  s_waitcnt lgkmcnt(3)
  v_mfma_f32_32x32x16_bf16 v[224:239], v[176:179], v[80:83], 0
  s_waitcnt lgkmcnt(2)
  v_mfma_f32_32x32x16_bf16 v[224:239], v[180:183], v[84:87], v[224:239]
  s_waitcnt lgkmcnt(1)
  v_mfma_f32_32x32x16_bf16 v[224:239], v[184:187], v[88:91], v[224:239]
  s_waitcnt lgkmcnt(0)
  v_mfma_f32_32x32x16_bf16 v[224:239], v[188:191], v[92:95], v[224:239]
Lt_g3:
  s_or_b32 s56, s55, s53
  s_cmp_eq_u32 s56, 31
  s_cbranch_scc1 Lt_done
  s_cmp_lt_u32 s61, 2097152
  s_cbranch_scc1 Lt
Lt_done:
  s_nop 6
  s_cmp_lg_u32 s47, 0
  s_cbranch_scc1 Lred1
  v_pk_mul_f32 v[120:121], v[120:121], v[22:23] op_sel:[0,1] op_sel_hi:[1,1]
  v_pk_mul_f32 v[122:123], v[122:123], v[22:23] op_sel:[0,1] op_sel_hi:[1,1]
  v_pk_mul_f32 v[124:125], v[124:125], v[22:23] op_sel:[0,1] op_sel_hi:[1,1]
  v_pk_mul_f32 v[126:127], v[126:127], v[22:23] op_sel:[0,1] op_sel_hi:[1,1]
  v_pk_add_f32 v[56:57], v[56:57], v[200:201]
  v_pk_add_f32 v[58:59], v[58:59], v[202:203]
  v_pk_add_f32 v[60:61], v[60:61], v[204:205]
  v_pk_add_f32 v[62:63], v[62:63], v[206:207]
  v_pk_add_f32 v[216:217], v[216:217], v[232:233]
  v_pk_add_f32 v[218:219], v[218:219], v[234:235]
  v_pk_add_f32 v[220:221], v[220:221], v[236:237]
  v_pk_add_f32 v[222:223], v[222:223], v[238:239]
  v_pk_add_f32 v[56:57], v[56:57], v[216:217]
  v_pk_add_f32 v[58:59], v[58:59], v[218:219]
  v_pk_add_f32 v[60:61], v[60:61], v[220:221]
  v_pk_add_f32 v[62:63], v[62:63], v[222:223]
  v_pk_fma_f32 v[120:121], v[56:57], v[22:23], v[120:121] op_sel_hi:[1,0,1]
  v_pk_fma_f32 v[122:123], v[58:59], v[22:23], v[122:123] op_sel_hi:[1,0,1]
  v_pk_fma_f32 v[124:125], v[60:61], v[22:23], v[124:125] op_sel_hi:[1,0,1]
  v_pk_fma_f32 v[126:127], v[62:63], v[22:23], v[126:127] op_sel_hi:[1,0,1]
  s_nop 0
  ds_write_b128 v19, v[120:123] offset:2048
  ds_write_b128 v19, v[124:127] offset:3072
  v_pk_mul_f32 v[112:113], v[112:113], v[22:23] op_sel:[0,1] op_sel_hi:[1,1]
  v_pk_mul_f32 v[114:115], v[114:115], v[22:23] op_sel:[0,1] op_sel_hi:[1,1]
  v_pk_mul_f32 v[116:117], v[116:117], v[22:23] op_sel:[0,1] op_sel_hi:[1,1]
  v_pk_mul_f32 v[118:119], v[118:119], v[22:23] op_sel:[0,1] op_sel_hi:[1,1]
  v_pk_add_f32 v[48:49], v[48:49], v[192:193]
  v_pk_add_f32 v[50:51], v[50:51], v[194:195]
  v_pk_add_f32 v[52:53], v[52:53], v[196:197]
  v_pk_add_f32 v[54:55], v[54:55], v[198:199]
  v_pk_add_f32 v[208:209], v[208:209], v[224:225]
  v_pk_add_f32 v[210:211], v[210:211], v[226:227]
  v_pk_add_f32 v[212:213], v[212:213], v[228:229]
  v_pk_add_f32 v[214:215], v[214:215], v[230:231]
  v_pk_add_f32 v[48:49], v[48:49], v[208:209]
  v_pk_add_f32 v[50:51], v[50:51], v[210:211]
  v_pk_add_f32 v[52:53], v[52:53], v[212:213]
  v_pk_add_f32 v[54:55], v[54:55], v[214:215]
  v_pk_fma_f32 v[112:113], v[48:49], v[22:23], v[112:113] op_sel_hi:[1,0,1]
  v_pk_fma_f32 v[114:115], v[50:51], v[22:23], v[114:115] op_sel_hi:[1,0,1]
  v_pk_fma_f32 v[116:117], v[52:53], v[22:23], v[116:117] op_sel_hi:[1,0,1]
  v_pk_fma_f32 v[118:119], v[54:55], v[22:23], v[118:119] op_sel_hi:[1,0,1]
  s_waitcnt lgkmcnt(0)
  s_barrier
  ds_read_b128 v[64:67], v19 offset:0
  ds_read_b128 v[68:71], v19 offset:1024
  s_waitcnt lgkmcnt(0)
  v_add_f32 v64, v64, v112
  v_add_f32 v65, v65, v113
  v_add_f32 v66, v66, v114
  v_add_f32 v67, v67, v115
  v_add_f32 v68, v68, v116
  v_add_f32 v69, v69, v117
  v_add_f32 v70, v70, v118
  v_add_f32 v71, v71, v119
  s_branch Lred2
Lred1:
  v_pk_mul_f32 v[112:113], v[112:113], v[22:23] op_sel:[0,1] op_sel_hi:[1,1]
  v_pk_mul_f32 v[114:115], v[114:115], v[22:23] op_sel:[0,1] op_sel_hi:[1,1]
  v_pk_mul_f32 v[116:117], v[116:117], v[22:23] op_sel:[0,1] op_sel_hi:[1,1]
  v_pk_mul_f32 v[118:119], v[118:119], v[22:23] op_sel:[0,1] op_sel_hi:[1,1]
  v_pk_add_f32 v[48:49], v[48:49], v[192:193]
  v_pk_add_f32 v[50:51], v[50:51], v[194:195]
  v_pk_add_f32 v[52:53], v[52:53], v[196:197]
  v_pk_add_f32 v[54:55], v[54:55], v[198:199]
  v_pk_add_f32 v[208:209], v[208:209], v[224:225]
  v_pk_add_f32 v[210:211], v[210:211], v[226:227]
  v_pk_add_f32 v[212:213], v[212:213], v[228:229]
  v_pk_add_f32 v[214:215], v[214:215], v[230:231]
  v_pk_add_f32 v[48:49], v[48:49], v[208:209]
  v_pk_add_f32 v[50:51], v[50:51], v[210:211]
  v_pk_add_f32 v[52:53], v[52:53], v[212:213]
  v_pk_add_f32 v[54:55], v[54:55], v[214:215]
  v_pk_fma_f32 v[112:113], v[48:49], v[22:23], v[112:113] op_sel_hi:[1,0,1]
  v_pk_fma_f32 v[114:115], v[50:51], v[22:23], v[114:115] op_sel_hi:[1,0,1]
  v_pk_fma_f32 v[116:117], v[52:53], v[22:23], v[116:117] op_sel_hi:[1,0,1]
  v_pk_fma_f32 v[118:119], v[54:55], v[22:23], v[118:119] op_sel_hi:[1,0,1]
  s_nop 0
  ds_write_b128 v19, v[112:115] offset:0
  ds_write_b128 v19, v[116:119] offset:1024
  v_pk_mul_f32 v[120:121], v[120:121], v[22:23] op_sel:[0,1] op_sel_hi:[1,1]
  v_pk_mul_f32 v[122:123], v[122:123], v[22:23] op_sel:[0,1] op_sel_hi:[1,1]
  v_pk_mul_f32 v[124:125], v[124:125], v[22:23] op_sel:[0,1] op_sel_hi:[1,1]
  v_pk_mul_f32 v[126:127], v[126:127], v[22:23] op_sel:[0,1] op_sel_hi:[1,1]
  v_pk_add_f32 v[56:57], v[56:57], v[200:201]
  v_pk_add_f32 v[58:59], v[58:59], v[202:203]
  v_pk_add_f32 v[60:61], v[60:61], v[204:205]
  v_pk_add_f32 v[62:63], v[62:63], v[206:207]
  v_pk_add_f32 v[216:217], v[216:217], v[232:233]
  v_pk_add_f32 v[218:219], v[218:219], v[234:235]
  v_pk_add_f32 v[220:221], v[220:221], v[236:237]
  v_pk_add_f32 v[222:223], v[222:223], v[238:239]
  v_pk_add_f32 v[56:57], v[56:57], v[216:217]
  v_pk_add_f32 v[58:59], v[58:59], v[218:219]
  v_pk_add_f32 v[60:61], v[60:61], v[220:221]
  v_pk_add_f32 v[62:63], v[62:63], v[222:223]
  v_pk_fma_f32 v[120:121], v[56:57], v[22:23], v[120:121] op_sel_hi:[1,0,1]
  v_pk_fma_f32 v[122:123], v[58:59], v[22:23], v[122:123] op_sel_hi:[1,0,1]
  v_pk_fma_f32 v[124:125], v[60:61], v[22:23], v[124:125] op_sel_hi:[1,0,1]
  v_pk_fma_f32 v[126:127], v[62:63], v[22:23], v[126:127] op_sel_hi:[1,0,1]
  s_waitcnt lgkmcnt(0)
  s_barrier
  ds_read_b128 v[64:67], v19 offset:2048
  ds_read_b128 v[68:71], v19 offset:3072
  s_waitcnt lgkmcnt(0)
  v_add_f32 v64, v64, v120
  v_add_f32 v65, v65, v121
  v_add_f32 v66, v66, v122
  v_add_f32 v67, v67, v123
  v_add_f32 v68, v68, v124
  v_add_f32 v69, v69, v125
  v_add_f32 v70, v70, v126
  v_add_f32 v71, v71, v127
Lred2:
  v_cvt_pk_bf16_f32 v72, v64, v65
  v_cvt_pk_bf16_f32 v73, v66, v67
  v_cvt_pk_bf16_f32 v74, v68, v69
  v_cvt_pk_bf16_f32 v75, v70, v71
  s_nop 1
  v_permlane32_swap_b32 v72, v74
  v_permlane32_swap_b32 v73, v75
  buffer_store_dwordx4 v[72:75], v11, s[36:39], s64 offen
Lend:
  s_endpgm
Lfallback:
  s_setprio 0
  s_mov_b32 s54, 1
  v_mov_b32 v14, v2
  s_mov_b32 s55, 0
  v_mov_b32 v9, 0xff800000
Lmaxloop:
  ds_read_b128 v[96:99], v14
  v_add_u32 v14, 2080, v14
  s_waitcnt lgkmcnt(0)
  v_mfma_f32_32x32x16_bf16 v[64:79], v[96:99], v[28:31], 0
  s_nop 11
  v_max3_f32 v9, v9, v64, v65
  v_max3_f32 v9, v9, v66, v67
  v_max3_f32 v9, v9, v68, v69
  v_max3_f32 v9, v9, v70, v71
  v_max3_f32 v9, v9, v72, v73
  v_max3_f32 v9, v9, v74, v75
  v_max3_f32 v9, v9, v76, v77
  v_max3_f32 v9, v9, v78, v79
  s_add_u32 s55, s55, 1
  s_cmp_lt_u32 s55, 64
  s_cbranch_scc1 Lmaxloop
  v_mov_b32 v10, v9
  s_nop 1
  v_permlane32_swap_b32 v9, v10
  v_max_f32 v9, v9, v10
  v_sub_f32 v32, 0, v9
  v_sub_f32 v33, 0, v9
  v_sub_f32 v34, 0, v9
  v_sub_f32 v35, 0, v9
  v_sub_f32 v36, 0, v9
  v_sub_f32 v37, 0, v9
  v_sub_f32 v38, 0, v9
  v_sub_f32 v39, 0, v9
  v_sub_f32 v40, 0, v9
  v_sub_f32 v41, 0, v9
  v_sub_f32 v42, 0, v9
  v_sub_f32 v43, 0, v9
  v_sub_f32 v44, 0, v9
  v_sub_f32 v45, 0, v9
  v_sub_f32 v46, 0, v9
  v_sub_f32 v47, 0, v9
  v_mov_b32 v48, 0
  v_mov_b32 v49, 0
  v_mov_b32 v50, 0
  v_mov_b32 v51, 0
  v_mov_b32 v52, 0
  v_mov_b32 v53, 0
  v_mov_b32 v54, 0
  v_mov_b32 v55, 0
  v_mov_b32 v56, 0
  v_mov_b32 v57, 0
  v_mov_b32 v58, 0
  v_mov_b32 v59, 0
  v_mov_b32 v60, 0
  v_mov_b32 v61, 0
  v_mov_b32 v62, 0
  v_mov_b32 v63, 0
  v_mov_b32 v14, v2
  v_mov_b32 v15, v7
  v_mov_b32 v16, v8
  s_mov_b32 s55, 0
Lloop2:
  ds_read_b128 v[96:99], v14
  ds_read_b128 v[100:103], v15
  ds_read_b128 v[104:107], v16
  v_add_u32 v14, 2080, v14
  v_add_u32 v15, 2080, v15
  v_add_u32 v16, 2080, v16
  s_waitcnt lgkmcnt(0)
  v_mfma_f32_32x32x16_bf16 v[64:79], v[96:99], v[28:31], v[32:47]
  s_nop 11
  v_exp_f32 v64, v64
  v_exp_f32 v65, v65
  v_exp_f32 v66, v66
  v_exp_f32 v67, v67
  v_exp_f32 v68, v68
  v_exp_f32 v69, v69
  v_exp_f32 v70, v70
  v_exp_f32 v71, v71
  v_exp_f32 v72, v72
  v_exp_f32 v73, v73
  v_exp_f32 v74, v74
  v_exp_f32 v75, v75
  v_exp_f32 v76, v76
  v_exp_f32 v77, v77
  v_exp_f32 v78, v78
  v_exp_f32 v79, v79
  s_nop 1
  v_smfmac_f32_32x32x32_bf16 v[48:63], v[100:103], v[64:71], v13
  v_smfmac_f32_32x32x32_bf16 v[48:63], v[104:107], v[72:79], v13
  s_nop 7
  s_add_u32 s55, s55, 1
  s_cmp_lt_u32 s55, 64
  s_cbranch_scc1 Lloop2
  s_branch Lfinish
Lcode_end:
.section .rodata,"a"
.p2align 6
.amdhsa_kernel gated_mix__mha_block__sliding_local_dilated__prompt_kernel
  .amdhsa_next_free_vgpr 256
  .amdhsa_next_free_sgpr 102
  .amdhsa_accum_offset 256
  .amdhsa_group_segment_fixed_size 0
  .amdhsa_kernarg_size 80
  .amdhsa_user_sgpr_count 2
  .amdhsa_user_sgpr_kernarg_segment_ptr 1
  .amdhsa_system_sgpr_workgroup_id_x 1
.end_amdhsa_kernel
```
